```python
import torch

def _softmax(x, axis=-1):
    return torch.softmax(x, dim=axis)
def _gelu(x):
    return torch.nn.functional.gelu(x, approximate="tanh")
def _silu(x):
    return torch.nn.functional.silu(x)
def _sigmoid(x):
    return torch.sigmoid(x)
def _layernorm(x, axis=-1, eps=1e-5):
    m = x.mean(dim=axis, keepdim=True)
    v = x.var(dim=axis, keepdim=True, unbiased=False)
    return (x - m) / torch.sqrt(v + eps)
def _scatter_add(tgt, idx, src, axis=0):
    return tgt.clone().index_add_(axis, idx, src)
def _segment_sum(src, seg, n):
    out = torch.zeros((n,) + src.shape[1:], dtype=src.dtype)
    return out.index_add_(0, seg, src)
def _pad(x, pw):
    flat = tuple(v for pair in reversed(pw) for v in pair)
    return torch.nn.functional.pad(x, flat)

kernel_name = 'gated_mix__ssm_conv_s5__linear_attn_block__prompt'

def setup_inputs():

    _w = (lambda a: (lambda t: t.to(torch.bfloat16) if t.is_floating_point() else t)(torch.as_tensor(a)))
    def _A_setup():
        B, S, D = 1, 2048, 640
        P = D
        Lambda_re = -0.5 * (lambda _x: torch.exp(torch.as_tensor(_x)))((lambda *s: torch.randn(*s, dtype=torch.bfloat16) * 0.2)(P))
        Lambda_im = (lambda *s: torch.randn(*s, dtype=torch.bfloat16) * 0.8)(P) * 1.0
        B_re = (lambda *s: torch.randn(*s, dtype=torch.bfloat16) * 0.4)(P, D) * (D ** -0.5)
        B_im = (lambda *s: torch.randn(*s, dtype=torch.bfloat16) * 0.4)(P, D) * (D ** -0.5)
        C_re = (lambda *s: torch.randn(*s, dtype=torch.bfloat16) * 0.4)(D, P) * (P ** -0.5)
        C_im = (lambda *s: torch.randn(*s, dtype=torch.bfloat16) * 0.4)(D, P) * (P ** -0.5)
        log_dt = (lambda *s: torch.randn(*s, dtype=torch.bfloat16) * 0.2)(P) * 0.3 - 2.0
        Dskip = (lambda *s: torch.randn(*s, dtype=torch.bfloat16) * 0.05)(D)
        return {
            "x": _w((lambda *s: torch.randn(*s, dtype=torch.bfloat16) * 0.05)(B, S, D)),
            "Lambda_re": _w(Lambda_re),
            "Lambda_im": _w(Lambda_im),
            "B_re": _w(B_re),
            "B_im": _w(B_im),
            "C_re": _w(C_re),
            "C_im": _w(C_im),
            "log_dt": _w(log_dt),
            "Dskip": _w(Dskip),
        }
    _A_in = _A_setup()

    def _B_setup():
        B, S, D = 1, 2048, 640
        return {
            "x": _w((lambda *s: torch.randn(*s, dtype=torch.bfloat16) * 0.05)(B, S, D)),
            "wqkv": _w((lambda *s: torch.randn(*s, dtype=torch.bfloat16) * 0.8)(D, 3 * D)),
            "wo": _w((lambda *s: torch.randn(*s, dtype=torch.bfloat16) * 0.05)(D, D)),
        }
    _B_in = _B_setup()

    return {
        "A_x": _A_in["x"],
        "A_Lambda_re": _A_in["Lambda_re"],
        "A_Lambda_im": _A_in["Lambda_im"],
        "A_B_re": _A_in["B_re"],
        "A_B_im": _A_in["B_im"],
        "A_C_re": _A_in["C_re"],
        "A_C_im": _A_in["C_im"],
        "A_log_dt": _A_in["log_dt"],
        "A_Dskip": _A_in["Dskip"],
        "B_x": _B_in["x"],
        "B_wqkv": _B_in["wqkv"],
        "B_wo": _B_in["wo"],
        "gate_w": _w((lambda *s: torch.randn(*s, dtype=torch.bfloat16) * 0.05)(640) * 16.0),
    }

def reference(A_x, A_Lambda_re, A_Lambda_im, A_B_re, A_B_im, A_C_re, A_C_im, A_log_dt, A_Dskip, B_x, B_wqkv, B_wo, gate_w):
    def _A_ref(x, Lambda_re, Lambda_im, B_re, B_im, C_re, C_im, log_dt, Dskip):
        Bsz, L, H = x.shape
        Lam = Lambda_re + 1j * Lambda_im
        Bmat = B_re + 1j * B_im
        Cmat = C_re + 1j * C_im
        dt = torch.exp(log_dt)
        Lam_bar = torch.exp(dt * Lam)
        B_bar = ((Lam_bar - 1.0) / Lam)[:, None] * Bmat
        Bu = torch.einsum("bld,pd->blp", x + 0j, B_bar)
        h = torch.zeros_like(Bu[:, 0, :])
        hs = []
        for t in range(L):
            h = Lam_bar[None, :] * h + Bu[:, t, :]
            hs.append(h)
        hseq = torch.stack(hs, 1)
        y = 2.0 * torch.einsum("blp,dp->bld", hseq, Cmat).real + x * Dskip[None, None, :]
        return y

    def _B_ref(x, wqkv, wo):
        B, S, D = x.shape
        H = 32; Dh = D // H
        qkv = (lambda x, *d: x.permute(*d))((x @ wqkv).reshape(B, S, 3, H, Dh), 2, 0, 3, 1, 4)
        q, k, v = qkv[0], qkv[1], qkv[2]
        phi = lambda t: torch.where(t > 0, t + 1, torch.exp(t)) + 1e-6
        pq, pk = phi(q), phi(k)
        kv = torch.einsum("bhsd,bhse->bhde", pk, v)
        z = torch.einsum("bhsd->bhd", pk)
        num = torch.einsum("bhqd,bhde->bhqe", pq, kv)
        den = torch.einsum("bhqd,bhd->bhq", pq, z)[..., None] + 1e-6
        o = num / den
        return (lambda x, *d: x.permute(*d))(o, 0, 2, 1, 3).reshape(B, S, D) @ wo

    x = A_x
    g = _sigmoid((x * gate_w).sum(-1, keepdims=True))
    a = _A_ref(x, A_Lambda_re, A_Lambda_im, A_B_re, A_B_im, A_C_re, A_C_im, A_log_dt, A_Dskip)
    b = _B_ref(x, B_wqkv, B_wo)
    return g * a + (1 - g) * b
```

```asm
; @launch grid=(256,1,1) block=(256,1,1) lds=163840
.amdgcn_target "amdgcn-amd-amdhsa--gfx950"
.text
.globl gated_mix__ssm_conv_s5__linear_attn_block__prompt_kernel
.p2align 8
.type gated_mix__ssm_conv_s5__linear_attn_block__prompt_kernel,@function
gated_mix__ssm_conv_s5__linear_attn_block__prompt_kernel:
    s_cmp_ge_u32 s2, 256
    s_cbranch_scc1 L_end
    s_load_dwordx16 s[16:31], s[0:1], 0
    s_load_dwordx16 s[32:47], s[0:1], 64
    s_getpc_b64 s[80:81]
L_pc0:
    s_mov_b32 s82, L_codeend-L_pc0
    s_mov_b32 s83, 0x20000
    s_lshr_b32 s12, s2, 3
    s_lshl_b32 s13, s12, 10
    v_lshrrev_b32 v29, 5, v0
    v_lshlrev_b32 v29, 7, v29
    buffer_load_dword v255, v29, s[80:83], s13 offen
    v_lshrrev_b32 v28, 6, v0
    v_and_b32 v1, 63, v0
    v_readfirstlane_b32 s3, v28
    s_nop 0
    s_lshl_b32 s84, s3, 8
    s_add_u32 s84, s84, s2
    s_mul_i32 s85, s84, 6554
    s_lshr_b32 s85, s85, 16
    s_mul_i32 s11, s85, 10
    s_sub_u32 s89, s84, s11
    s_lshl_b32 s87, s3, 12
    s_add_u32 s87, s87, 61440
    s_mul_i32 s90, s85, 30720
    s_mul_i32 s11, s89, 384
    s_add_u32 s90, s90, s11
    s_mul_i32 s11, s85, 205
    s_lshr_b32 s11, s11, 10
    s_mul_i32 s11, s11, 5
    s_sub_u32 s13, s85, s11
    s_add_u32 s11, s11, s85
    s_mul_i32 s11, s11, 5120
    s_lshl_b32 s14, s89, 7
    s_add_u32 s91, s11, s14
    s_cmp_lt_u32 s13, 4
    s_cselect_b32 s13, 25600, 0
    s_cmp_lt_u32 s84, 800
    s_cselect_b32 s58, 27264, 0
    s_cselect_b32 s78, 34688, 0
    s_mov_b32 s59, 0x20000
    s_mov_b32 s79, 0x20000
    v_lshrrev_b32 v28, 3, v1
    v_and_b32 v31, 7, v1
    v_lshlrev_b32 v29, 4, v31
    v_mul_u32_u24 v96, 3840, v28
    v_add_u32 v96, v96, v29
    v_mul_u32_u24 v184, 1280, v28
    v_add_u32 v97, v184, v29
    v_lshrrev_b32 v29, 2, v28
    v_mad_u32_u24 v97, v29, s13, v97
    s_or_b32 s96, s2, s3
    s_mov_b32 s97, s2
    s_and_b32 s88, s3, 1
    s_and_b32 s11, s2, 7
    s_waitcnt lgkmcnt(0)
    s_cmp_lg_u32 s84, 800
    s_cbranch_scc1 L_noclear_1
    v_lshlrev_b32 v32, 7, v1
    v_mov_b32 v33, 0
    v_add_u32 v34, 8192, v32
    v_add_u32 v35, 16384, v32
    global_store_dword v32, v33, s[46:47] sc1
    global_store_dword v34, v33, s[46:47] sc1
    global_store_dword v35, v33, s[46:47] sc1
    v_mov_b32 v27, 1
    s_waitcnt vmcnt(0)
    global_store_dword v33, v27, s[44:45] sc1
L_noclear_1:
    s_add_u32 s56, s36, s90
    s_addc_u32 s57, s37, 0
    s_add_u32 s76, s38, s91
    s_addc_u32 s77, s39, 0
    s_add_u32 m0, s87, 0
    s_nop 0
    buffer_load_dwordx4 v96, s[56:59], 0 offen offset:0 lds
    s_add_u32 m0, s87, 896
    s_nop 0
    buffer_load_dwordx4 v96, s[56:59], 0 offen offset:128 lds
    s_add_u32 m0, s87, 1792
    s_nop 0
    buffer_load_dwordx4 v96, s[56:59], 0 offen offset:256 lds
    s_add_u32 m0, s87, 3072
    s_nop 0
    buffer_load_dwordx4 v97, s[76:79], 0 offen lds
    s_and_b32 s4, s11, 1
    s_lshl_b32 s4, s4, 3
    s_and_b32 s13, s12, 7
    s_add_u32 s4, s4, s13
    s_lshr_b32 s5, s11, 1
    s_lshl_b32 s5, s5, 2
    s_lshr_b32 s13, s12, 3
    s_add_u32 s5, s5, s13
    s_add_u32 s14, s4, s5
    s_mul_i32 s14, s14, 1
    s_mul_i32 s13, s14, 205
    s_lshr_b32 s13, s13, 11
    s_mul_i32 s13, s13, 10
    s_sub_u32 s14, s14, s13
    v_lshrrev_b32 v3, 4, v1
    s_mul_i32 s8, s3, 17408
    s_add_u32 s8, s8, 81920
    v_xor_b32 v29, v31, v3
    v_lshlrev_b32 v29, 4, v29
    v_and_b32 v30, 4, v28
    s_lshl_b32 s13, s3, 5
    v_add3_u32 v30, v30, v28, s13
    v_mul_u32_u24 v30, 1280, v30
    v_add_u32 v11, v30, v29
    v_xor_b32 v12, 64, v11
    v_add_u32 v12, 19456, v12
    v_add_u32 v13, 3072, v11
    v_add_u32 v14, 3072, v12
    s_mul_i32 s11, s4, 163840
    s_lshl_b32 s0, s14, 7
    s_add_u32 s48, s16, s11
    s_addc_u32 s49, s17, 0
    s_mov_b32 s50, 0x28000
    s_mov_b32 s51, 0x20000
    s_add_u32 m0, s8, 0
    s_nop 0
    buffer_load_dwordx4 v11, s[48:51], s0 offen offset:0 lds
    buffer_load_dwordx4 v12, s[48:51], s0 offen offset:1024 lds
    buffer_load_dwordx4 v13, s[48:51], s0 offen offset:2048 lds
    buffer_load_dwordx4 v14, s[48:51], s0 offen offset:3072 lds
    s_cmp_lt_u32 s3, 2
    s_cselect_b32 s22, s22, s24
    s_cselect_b32 s23, s23, s25
    s_cselect_b32 s26, s26, s28
    s_cselect_b32 s27, s27, s29
    s_mul_i32 s12, s5, 51200
    s_add_u32 s52, s22, s12
    s_addc_u32 s53, s23, 0
    s_mov_b32 s54, 0xc800
    s_mov_b32 s55, 0x20000
    s_mul_i32 s10, s88, 10240
    s_lshr_b32 s12, s3, 1
    s_mul_i32 s13, s12, 5120
    s_add_u32 s10, s10, s13
    s_lshl_b32 s12, s12, 6
    s_lshl_b32 s13, s88, 7
    s_add_u32 s1, s0, s13
    v_add_u32 v184, v184, v29
    v_xor_b32 v15, s12, v184
    v_add_u32 v16, 9216, v15
    v_add_u32 v17, 18432, v15
    v_add_u32 v18, 27648, v15
    v_add_u32 v19, 40960, v15
    s_mul_i32 s12, s5, 40
    v_min_u32 v241, 39, v1
    v_add_lshl_u32 v29, v241, s12, 1
    global_load_ushort v232, v29, s[18:19]
    global_load_ushort v233, v29, s[20:21]
    global_load_ushort v234, v29, s[30:31]
    v_lshlrev_b32 v20, 4, v1
    v_and_b32 v2, 15, v1
    s_mov_b32 s64, s46
    s_mov_b32 s65, s47
    s_mov_b32 s66, 0x1000000
    s_mov_b32 s67, 0x20000
    s_mov_b32 s72, s44
    s_mov_b32 s73, s45
    s_mov_b32 s74, 0x100
    s_mov_b32 s75, 0x20000
    s_and_b32 s6, s5, 7
    s_lshr_b32 s7, s5, 3
    s_mul_i32 s9, s3, 5120
    s_lshl_b32 s11, s85, 1
    s_and_b32 s11, s11, 6
    s_bfe_u32 s12, s85, 0x10002
    s_or_b32 s11, s11, s12
    s_andn2_b32 s12, s85, 7
    s_or_b32 s11, s11, s12
    s_mul_i32 s37, s11, 640
    s_add_u32 s37, s37, 12582912
    s_mul_i32 s36, s85, 1280
    s_add_u32 s21, s36, 13631488
    s_add_u32 s36, s36, 10485120
    s_mul_i32 s13, s89, 3
    s_add_u32 s11, s13, 0
    s_mul_i32 s12, s11, 26
    s_lshr_b32 s12, s12, 8
    s_mul_i32 s12, s12, 640
    s_lshl_b32 s11, s11, 6
    s_sub_u32 s11, s11, s12
    s_add_u32 s18, s36, s12
    s_cmp_eq_u32 s12, 0
    s_cselect_b32 s18, s37, s18
    s_cselect_b32 s12, 0, 51200
    s_add_u32 s12, s12, 50560
    v_add_u32 v28, s11, v1
    v_mul_u32_u24 v29, 1639, v28
    v_lshrrev_b32 v29, 16, v29
    v_lshlrev_b32 v28, 4, v28
    v_mad_u32_u24 v98, v29, s12, v28
    s_add_u32 s11, s13, 1
    s_mul_i32 s12, s11, 26
    s_lshr_b32 s12, s12, 8
    s_mul_i32 s12, s12, 640
    s_lshl_b32 s11, s11, 6
    s_sub_u32 s11, s11, s12
    s_add_u32 s19, s36, s12
    s_cmp_eq_u32 s12, 0
    s_cselect_b32 s19, s37, s19
    s_cselect_b32 s12, 0, 51200
    s_add_u32 s12, s12, 50560
    v_add_u32 v28, s11, v1
    v_mul_u32_u24 v29, 1639, v28
    v_lshrrev_b32 v29, 16, v29
    v_lshlrev_b32 v28, 4, v28
    v_mad_u32_u24 v99, v29, s12, v28
    s_add_u32 s11, s13, 2
    s_mul_i32 s12, s11, 26
    s_lshr_b32 s12, s12, 8
    s_mul_i32 s12, s12, 640
    s_lshl_b32 s11, s11, 6
    s_sub_u32 s11, s11, s12
    s_add_u32 s20, s36, s12
    s_cmp_eq_u32 s12, 0
    s_cselect_b32 s20, s37, s20
    s_cselect_b32 s12, 0, 51200
    s_add_u32 s12, s12, 50560
    v_add_u32 v28, s11, v1
    v_mul_u32_u24 v29, 1639, v28
    v_lshrrev_b32 v29, 16, v29
    v_lshlrev_b32 v28, 4, v28
    v_mad_u32_u24 v100, v29, s12, v28
    s_lshl_b32 s11, s89, 6
    s_mov_b32 s12, 101120
    v_add_u32 v28, s11, v1
    v_mul_u32_u24 v29, 1639, v28
    v_lshrrev_b32 v29, 17, v29
    v_lshlrev_b32 v28, 4, v28
    v_mad_u32_u24 v101, v29, s12, v28
    s_lshr_b32 s30, s85, 1
    s_lshl_b32 s30, s30, 7
    s_add_u32 s30, s30, 2048
    s_cmp_lt_u32 s84, 800
    s_cselect_b32 s18, s18, 0x70000000
    s_cselect_b32 s19, s19, 0x70000000
    s_cselect_b32 s20, s20, 0x70000000
    s_cselect_b32 s21, s21, 0x70000000
    s_cselect_b32 s30, s30, 0x70000000
    v_and_b32 v28, 3, v1
    v_lshl_add_u32 v28, v3, 2, v28
    v_bfe_u32 v29, v1, 2, 2
    v_lshlrev_b32 v29, 7, v29
    v_lshl_add_u32 v28, v28, 3, v29
    v_add_u32 v74, s87, v28
    v_mov_b32 v27, 1
    s_add_u32 m0, s10, 0
    s_add_u32 s15, s1, 0
    s_sub_u32 s31, s15, 1280
    s_min_u32 s15, s15, s31
    buffer_load_dwordx4 v15, s[52:55], s15 offen offset:0 lds
    buffer_load_dwordx4 v16, s[52:55], s15 offen offset:1024 lds
    buffer_load_dwordx4 v17, s[52:55], s15 offen offset:2048 lds
    buffer_load_dwordx4 v18, s[52:55], s15 offen offset:3072 lds
    s_add_u32 m0, s10, 4096
    s_nop 0
    buffer_load_dwordx4 v19, s[52:55], s15 offen lds
    v_lshrrev_b32 v28, 1, v2
    v_xor_b32 v28, v28, v3
    v_lshlrev_b32 v28, 4, v28
    v_lshl_add_u32 v29, v2, 7, v28
    v_add_u32 v4, s8, v29
    v_xor_b32 v5, 64, v4
    v_lshrrev_b32 v31, 3, v2
    v_mul_u32_u24 v31, 4096, v31
    v_add_u32 v6, v29, v31
    v_xor_b32 v7, 64, v6
    v_add_u32 v8, 40960, v6
    v_add_u32 v9, 40960, v7
    s_lshl_b32 s13, s97, 1
    s_add_u32 s13, s13, s88
    s_mul_i32 s13, s13, 1600
    s_mov_b32 s97, 0x40000
    v_min_u32 v28, 12, v1
    v_lshl_add_u32 v75, v28, 7, s13
    s_mov_b32 s80, s26
    s_mov_b32 s81, s27
    s_mov_b32 s82, 0xc8000
    s_mov_b32 s83, 0x20000
    s_mov_b32 s94, 0x3fb8aa3b
    s_mov_b32 s95, 0x358637bd
    v_xor_b32 v185, 64, v184
    v_add_u32 v185, 9216, v185
    s_mul_i32 s36, s5, 51200
    s_add_u32 s36, s36, 12582912
    s_mul_i32 s37, s6, 102400
    s_add_u32 s37, s37, 13631488
    s_mul_i32 s16, s5, 102400
    s_add_u32 s16, s16, 10485760
    v_lshlrev_b32 v72, 7, v241
    v_add_u32 v72, 2048, v72
    s_lshl_b32 s13, s88, 6
    v_add_u32 v30, s13, v1
    v_add_u32 v29, 64, v2
    v_min_u32 v30, v30, v29
    v_lshlrev_b32 v21, 2, v30
    s_lshl_b32 s12, s5, 13
    s_add_u32 s12, s12, 65536
    s_add_u32 s76, s46, s12
    s_addc_u32 s77, s47, 0
    s_mov_b32 s78, 0x2000
    s_mov_b32 s79, 0x20000
    s_sub_u32 s34, 15, s4
    s_lshl_b32 s34, s34, 9
    s_lshl_b32 s25, s5, 2
    s_add_u32 s25, s25, s3
    s_lshl_b32 s25, s25, 13
    s_add_u32 s25, s25, 262144
    s_lshl_b32 s35, s4, 9
    s_add_u32 s35, s35, s25
    v_mov_b32 v120, -1
    v_mov_b32 v121, -1
    v_mov_b32 v122, -1
    v_mov_b32 v123, -1
    v_and_b32 v124, 32, v1
    v_mul_u32_u24 v124, 240, v124
    v_add_u32 v124, v124, v20
    s_lshl_b32 s86, s3, 13
    s_add_u32 s86, s86, s35
    s_lshl_b32 s84, s5, 7
    s_mul_i32 s13, s88, 640
    s_mul_i32 s12, s6, 102400
    s_add_u32 s12, s12, s13
    s_add_u32 s60, s26, s12
    s_addc_u32 s61, s27, 0
    s_sub_u32 s62, 102400, s13
    s_mov_b32 s63, 0x20000
    s_lshl_b32 s12, s4, 1
    s_add_u32 s12, s12, s7
    s_mul_i32 s12, s12, 163840
    s_mul_i32 s13, s6, 320
    s_add_u32 s12, s12, s13
    s_add_u32 s68, s42, s12
    s_addc_u32 s69, s43, 0
    s_sub_u32 s70, 163840, s13
    s_mov_b32 s71, 0x20000
    buffer_load_dword v255, v75, s[80:83], 0 offen
    s_lshr_b32 s13, s3, 1
    s_mul_i32 s13, s13, 10240
    s_mul_i32 s2, s0, 80
    s_add_u32 s2, s2, s13
    s_mul_i32 s38, s0, 40
    s_add_u32 s38, s38, s9
    s_add_u32 s17, s34, 512
    s_add_u32 s24, s34, 4608
    s_cmp_lt_u32 s3, 2
    s_cselect_b32 s40, s40, s32
    s_cselect_b32 s41, s41, s33
    s_mov_b32 s56, s40
    s_mov_b32 s57, s41
    s_mov_b32 s58, 0x500
    s_mov_b32 s59, 0x20000
    s_add_u32 m0, s8, 4096
    s_add_u32 s15, s0, 128
    s_sub_u32 s31, s15, 1280
    s_min_u32 s15, s15, s31
    buffer_load_dwordx4 v11, s[48:51], s15 offen offset:0 lds
    s_lshl_b32 s13, s88, 10
    s_add_u32 s12, s13, s0
    s_mul_i32 s11, s6, 160
    s_add_u32 s87, s13, 152064
    s_add_u32 s13, s13, 160512
    s_cmp_lt_u32 s3, 2
    s_cselect_b32 s12, s12, s11
    s_cselect_b32 s87, s87, s13
    buffer_load_dwordx4 v12, s[48:51], s15 offen offset:1024 lds
    v_add_u32 v73, s12, v20
    v_subrev_u32 v28, 1280, v73
    v_min_u32 v73, v73, v28
    s_lshl_b32 s85, s4, 10
    s_add_u32 s85, s85, 8192
    s_lshr_b32 s13, s3, 1
    s_lshl_b32 s13, s13, 7
    s_add_u32 s39, s85, s13
    buffer_load_dwordx4 v13, s[48:51], s15 offen offset:2048 lds
    s_lshl_b32 s12, s7, 7
    s_add_u32 s40, s85, s12
    s_add_u32 s45, s40, s12
    s_add_u32 s45, s45, s13
    s_add_u32 s45, s45, 256
    s_lshl_b32 s13, s3, 7
    s_add_u32 s41, s85, s13
    s_add_u32 s41, s41, 256
    s_add_u32 s28, s37, s9
    s_mul_i32 s13, s88, 5120
    s_add_u32 s16, s16, s13
    buffer_load_dwordx4 v14, s[48:51], s15 offen offset:3072 lds
    s_lshl_b32 s13, s4, 2
    s_add_u32 s13, s13, s3
    s_mul_i32 s13, s13, 122880
    s_mul_i32 s12, s5, 1280
    s_add_u32 s13, s13, s12
    s_add_u32 s96, s13, 2097152
    s_cmp_lt_u32 s3, 2
    s_cselect_b64 s[46:47], -1, 0
    v_mul_u32_u24 v28, 80, v2
    v_add_u32 v142, 154120, v28
    s_add_u32 m0, s8, 8192
    s_add_u32 s15, s0, 256
    s_sub_u32 s31, s15, 1280
    s_min_u32 s15, s15, s31
    buffer_load_dwordx4 v11, s[48:51], s15 offen offset:0 lds
    v_lshl_add_u32 v28, v3, 2, v28
    s_lshl_b32 s11, s3, 4
    s_add_u32 s11, s11, 154124
    v_add_u32 v190, s11, v28
    v_mul_u32_u24 v186, 20, v21
    v_add_u32 v186, 154112, v186
    s_cmp_lt_u32 s3, 2
    s_cselect_b32 s11, 8, 4
    v_add_u32 v143, s11, v186
    v_and_b32 v29, 3, v1
    buffer_load_dwordx4 v12, s[48:51], s15 offen offset:1024 lds
    v_lshlrev_b32 v29, 8, v29
    v_and_b32 v30, 44, v1
    v_lshl_add_u32 v29, v30, 2, v29
    v_and_b32 v30, 16, v1
    v_lshrrev_b32 v30, 1, v30
    s_add_u32 s11, s8, 12288
    v_add_u32 v187, s11, v20
    v_add3_u32 v188, v29, v30, s11
    v_and_b32 v30, 1, v3
    v_mul_u32_u24 v30, 61440, v30
    v_lshrrev_b32 v31, 1, v3
    buffer_load_dwordx4 v13, s[48:51], s15 offen offset:2048 lds
    v_mul_u32_u24 v31, 20480, v31
    v_lshlrev_b32 v28, 4, v2
    v_add3_u32 v189, v30, v31, v28
    s_lshl_b32 s11, s3, 12
    s_add_u32 s11, s11, 20480
    v_add_u32 v191, s11, v20
    v_mov_b32 v141, 0
    v_mov_b32 v10, 0xb5c1a2a0
    s_lshl_b32 s12, s4, 1
    s_add_u32 s12, s12, s7
    buffer_load_dwordx4 v14, s[48:51], s15 offen offset:3072 lds
    s_mul_i32 s12, s12, 245760
    s_add_u32 s12, s12, 2097152
    s_mul_i32 s13, s3, 61440
    s_add_u32 s22, s12, s13
    s_add_u32 s22, s22, 40960
    s_add_u32 s23, s22, 16384
    s_mul_i32 s13, s3, 10240
    s_add_u32 s12, s12, s13
    s_add_u32 s13, s3, 0
    s_and_b32 s13, s13, 3
    s_add_u32 m0, s10, 20480
    s_add_u32 s15, s1, 256
    s_sub_u32 s31, s15, 1280
    s_min_u32 s15, s15, s31
    buffer_load_dwordx4 v15, s[52:55], s15 offen offset:0 lds
    s_mul_i32 s13, s13, 61440
    s_add_u32 s90, s13, s12
    s_add_u32 s13, s3, 1
    s_and_b32 s13, s13, 3
    s_mul_i32 s13, s13, 61440
    s_add_u32 s91, s13, s12
    s_add_u32 s13, s3, 2
    s_and_b32 s13, s13, 3
    s_mul_i32 s13, s13, 61440
    s_add_u32 s92, s13, s12
    s_add_u32 s13, s3, 3
    buffer_load_dwordx4 v16, s[52:55], s15 offen offset:1024 lds
    s_and_b32 s13, s13, 3
    s_mul_i32 s13, s13, 61440
    s_add_u32 s93, s13, s12
    v_cmp_gt_u32 vcc, 8, v2
    v_mul_u32_u24 v29, 1280, v3
    v_add3_u32 v29, v29, v28, v141
    v_add_u32 v29, 41216, v29
    v_lshlrev_b32 v30, 4, v3
    v_add_u32 v30, 152064, v30
    v_cndmask_b32 v76, v30, v29, vcc
    buffer_load_dwordx4 v17, s[52:55], s15 offen offset:2048 lds
    v_mov_b32 v29, 0x280
    v_cndmask_b32 v77, 64, v29, vcc
    v_mov_b32 v29, 0x1180
    v_cndmask_b32 v78, 64, v29, vcc
    v_mov_b32 v29, 0xfffed180
    v_cndmask_b32 v79, 64, v29, vcc
    s_waitcnt vmcnt(17)
    v_lshlrev_b32 v232, 16, v232
    v_lshlrev_b32 v233, 16, v233
    v_lshlrev_b32 v234, 16, v234
    v_mul_f32 v234, s94, v234
    buffer_load_dwordx4 v18, s[52:55], s15 offen offset:3072 lds
    v_exp_f32 v234, v234
    v_mul_u32_u24 v28, 48, v241
    v_add_u32 v28, 154112, v28
    v_cvt_pk_bf16_f32 v234, v234, v234
    v_lshlrev_b32 v234, 16, v234
    v_mul_f32 v246, v234, v232
    v_mul_f32 v246, s94, v246
    v_mul_f32 v247, v234, v233
    v_mul_f32 v247, 0.15915494, v247
    v_mul_f32 v235, 0x41000000, v246
    v_exp_f32 v235, v235
    s_add_u32 m0, s10, 24576
    s_nop 0
    buffer_load_dwordx4 v19, s[52:55], s15 offen lds
    v_mul_f32 v238, 0x41000000, v247
    v_fract_f32 v238, v238
    v_cos_f32 v236, v238
    v_sin_f32 v237, v238
    v_mul_f32 v248, v235, v236
    v_mul_f32 v249, v235, v237
    v_mul_f32 v235, 0x43000000, v246
    v_exp_f32 v235, v235
    v_mul_f32 v238, 0x43000000, v247
    v_fract_f32 v238, v238
    ds_read_b64_tr_b16 v[80:81], v74 offset:0
    ds_read_b64_tr_b16 v[82:83], v74 offset:512
    ds_read_b64_tr_b16 v[84:85], v74 offset:1024
    ds_read_b64_tr_b16 v[86:87], v74 offset:1536
    ds_read_b64_tr_b16 v[88:89], v74 offset:2048
    ds_read_b64_tr_b16 v[90:91], v74 offset:2560
    ds_read_b64_tr_b16 v[92:93], v74 offset:3072
    ds_read_b64_tr_b16 v[94:95], v74 offset:3584
    s_waitcnt lgkmcnt(0)
    buffer_store_dwordx4 v[80:83], v98, s[64:67], s18 offen sc1
    v_cos_f32 v236, v238
    v_sin_f32 v237, v238
    v_mul_f32 v250, v235, v236
    v_mul_f32 v251, v235, v237
    v_exp_f32 v235, v246
    v_fract_f32 v238, v247
    v_cos_f32 v236, v238
    v_sin_f32 v237, v238
    v_mul_f32 v242, v235, v236
    v_mul_f32 v243, v235, v237
    buffer_store_dwordx4 v[84:87], v99, s[64:67], s19 offen sc1
    v_add_f32 v238, -1.0, v242
    v_mul_f32 v239, v232, v232
    v_fmac_f32 v239, v233, v233
    v_rcp_f32 v239, v239
    v_mul_f32 v244, v238, v232
    v_fmac_f32 v244, v243, v233
    v_mul_f32 v245, v238, v233
    v_fma_f32 v245, -v243, v232, v245
    v_add_f32 v239, v239, v239
    v_mul_f32 v244, v244, v239
    v_mul_f32 v245, v245, v239
    buffer_store_dwordx4 v[88:91], v100, s[64:67], s20 offen sc1
    ds_write_b128 v28, v[242:245]
    ds_write_b128 v28, v[246:249] offset:16
    ds_write_b64 v28, v[250:251] offset:32
    v_and_b32 v28, 7, v2
    v_mul_u32_u24 v28, 48, v28
    v_add_u32 v28, 154112, v28
    ds_read_b128 v[192:195], v28 offset:0
    ds_read_b64 v[196:197], v28 offset:16
    ds_read_b128 v[198:201], v28 offset:384
    ds_read_b64 v[202:203], v28 offset:400
    buffer_store_dwordx4 v[92:95], v101, s[64:67], s21 offen sc1
    ds_read_b128 v[204:207], v28 offset:768
    ds_read_b64 v[208:209], v28 offset:784
    ds_read_b128 v[210:213], v28 offset:1152
    ds_read_b64 v[214:215], v28 offset:1168
    ds_read_b128 v[216:219], v28 offset:1536
    ds_read_b64 v[220:221], v28 offset:1552
    v_lshrrev_b32 v31, 6, v21
    v_mul_u32_u24 v31, 384, v31
    v_add_u32 v31, v31, v28
    ds_read_b64 v[22:23], v31 offset:24
    s_cmp_lt_u32 s3, 2
    s_cbranch_scc0 L_skip_2
    buffer_store_dwordx4 v[120:123], v124, s[64:67], s86 offen sc1
    buffer_store_dword v120, v21, s[76:79], s34 offen sc1
L_skip_2:
    buffer_load_dword v26, off, s[72:75], 0 offset:0 sc1
    ds_read_b64 v[24:25], v31 offset:32
    s_lshl_b32 s11, s3, 5
    v_lshl_add_u32 v29, v3, 3, s11
    v_cvt_f32_u32 v29, v29
    v_and_b32 v30, 8, v2
    v_lshlrev_b32 v30, 28, v30
    v_xor_b32 v31, v30, v29
    v_mov_b32 v222, s95
    v_mov_b32 v223, s95
    v_mov_b32 v224, s95
    s_waitcnt vmcnt(14)
    s_barrier
    ds_read_b128 a[0:3], v4 offset:0
    ds_read_b128 a[4:7], v4 offset:2048
    ds_read_b128 a[8:11], v5 offset:0
    ds_read_b128 a[12:15], v5 offset:2048
    ds_read_b128 v[144:147], v6 offset:0
    ds_read_b128 v[148:151], v6 offset:1024
    ds_read_b128 v[152:155], v6 offset:2048
    ds_read_b128 v[156:159], v6 offset:3072
    ds_read_b128 v[160:163], v6 offset:4096
    s_waitcnt lgkmcnt(4)
    v_mfma_f32_16x16x32_bf16 v[32:35], a[0:3], v[144:147], 0
    ds_read_b128 v[164:167], v7 offset:0
    s_add_u32 m0, s8, 12288
    s_add_u32 s15, s0, 384
    s_sub_u32 s31, s15, 1280
    s_min_u32 s15, s15, s31
    buffer_load_dwordx4 v11, s[48:51], s15 offen offset:0 lds
    v_mfma_f32_16x16x32_bf16 v[36:39], a[4:7], v[144:147], 0
    ds_read_b128 v[168:171], v7 offset:1024
    s_waitcnt lgkmcnt(4)
    v_mov_b32 v225, s95
    v_mfma_f32_16x16x32_bf16 v[40:43], a[0:3], v[148:151], 0
    ds_read_b128 v[172:175], v7 offset:2048
    buffer_load_dwordx4 v12, s[48:51], s15 offen offset:1024 lds
    v_mfma_f32_16x16x32_bf16 v[44:47], a[4:7], v[148:151], 0
    ds_read_b128 v[176:179], v7 offset:3072
    v_cmp_gt_u32 vcc, 8, v2
    v_mfma_f32_16x16x32_bf16 v[48:51], a[0:3], v[152:155], 0
    ds_read_b128 v[180:183], v7 offset:4096
    v_cndmask_b32 v226, 0, v222, vcc
    v_mfma_f32_16x16x32_bf16 v[52:55], a[4:7], v[152:155], 0
    ds_read_b128 a[16:19], v4 offset:4096
    s_waitcnt lgkmcnt(6)
    buffer_load_dwordx4 v13, s[48:51], s15 offen offset:2048 lds
    v_mfma_f32_16x16x32_bf16 v[56:59], a[0:3], v[156:159], 0
    ds_read_b128 a[20:23], v4 offset:6144
    v_cndmask_b32 v227, 0, v222, vcc
    v_mfma_f32_16x16x32_bf16 v[60:63], a[4:7], v[156:159], 0
    ds_read_b128 a[24:27], v5 offset:4096
    buffer_load_dwordx4 v14, s[48:51], s15 offen offset:3072 lds
    v_mfma_f32_16x16x32_bf16 v[64:67], a[0:3], v[160:163], 0
    ds_read_b128 a[28:31], v5 offset:6144
    v_cndmask_b32 v228, 0, v222, vcc
    v_mfma_f32_16x16x32_bf16 v[68:71], a[4:7], v[160:163], 0
    v_cndmask_b32 v229, 0, v222, vcc
    s_waitcnt lgkmcnt(8)
    v_mfma_f32_16x16x32_bf16 v[32:35], a[8:11], v[164:167], v[32:35]
    ds_read_b128 v[144:147], v6 offset:10240
    s_add_u32 m0, s8, 0
    s_add_u32 s15, s0, 512
    s_sub_u32 s31, s15, 1280
    s_min_u32 s15, s15, s31
    buffer_load_dwordx4 v11, s[48:51], s15 offen offset:0 lds
    v_mfma_f32_16x16x32_bf16 v[36:39], a[12:15], v[164:167], v[36:39]
    ds_read_b128 v[148:151], v6 offset:11264
    s_waitcnt lgkmcnt(8)
    v_mul_f32 v196, v196, v29
    v_mfma_f32_16x16x32_bf16 v[40:43], a[8:11], v[168:171], v[40:43]
    ds_read_b128 v[152:155], v6 offset:12288
    buffer_load_dwordx4 v12, s[48:51], s15 offen offset:1024 lds
    v_mfma_f32_16x16x32_bf16 v[44:47], a[12:15], v[168:171], v[44:47]
    ds_read_b128 v[156:159], v6 offset:13312
    v_mul_f32 v197, v197, v31
    v_mfma_f32_16x16x32_bf16 v[48:51], a[8:11], v[172:175], v[48:51]
    ds_read_b128 v[160:163], v6 offset:14336
    v_mul_f32 v202, v202, v29
    v_mfma_f32_16x16x32_bf16 v[52:55], a[12:15], v[172:175], v[52:55]
    s_waitcnt lgkmcnt(9)
    buffer_load_dwordx4 v13, s[48:51], s15 offen offset:2048 lds
    v_mfma_f32_16x16x32_bf16 v[56:59], a[8:11], v[176:179], v[56:59]
    v_mul_f32 v203, v203, v31
    v_mul_f32 v208, v208, v29
    v_mfma_f32_16x16x32_bf16 v[60:63], a[12:15], v[176:179], v[60:63]
    buffer_load_dwordx4 v14, s[48:51], s15 offen offset:3072 lds
    v_mfma_f32_16x16x32_bf16 v[64:67], a[8:11], v[180:183], v[64:67]
    v_mul_f32 v209, v209, v31
    v_mul_f32 v214, v214, v29
    v_mfma_f32_16x16x32_bf16 v[68:71], a[12:15], v[180:183], v[68:71]
    v_mul_f32 v215, v215, v31
    v_mul_f32 v220, v220, v29
    s_waitcnt lgkmcnt(4)
    v_mfma_f32_16x16x32_bf16 v[32:35], a[16:19], v[144:147], v[32:35]
    s_waitcnt vmcnt(8)
    v_readfirstlane_b32 s29, v26
    s_nop 0
    s_cmp_ge_u32 s29, 1
    s_cbranch_scc0 L_slow_3
L_back_4:
    s_mov_b64 exec, 1
    buffer_atomic_add v27, off, s[64:67], s30 sc1
    s_mov_b64 exec, -1
    ds_read_b128 v[164:167], v7 offset:10240
    s_add_u32 m0, s8, 4096
    s_add_u32 s15, s0, 640
    s_sub_u32 s31, s15, 1280
    s_min_u32 s15, s15, s31
    buffer_load_dwordx4 v11, s[48:51], s15 offen offset:0 lds
    v_mfma_f32_16x16x32_bf16 v[36:39], a[20:23], v[144:147], v[36:39]
    ds_read_b128 v[168:171], v7 offset:11264
    s_waitcnt lgkmcnt(4)
    v_mul_f32 v221, v221, v31
    v_mfma_f32_16x16x32_bf16 v[40:43], a[16:19], v[148:151], v[40:43]
    ds_read_b128 v[172:175], v7 offset:12288
    buffer_load_dwordx4 v12, s[48:51], s15 offen offset:1024 lds
    v_mfma_f32_16x16x32_bf16 v[44:47], a[20:23], v[148:151], v[44:47]
    ds_read_b128 v[176:179], v7 offset:13312
    v_exp_f32 v196, v196
    v_mfma_f32_16x16x32_bf16 v[48:51], a[16:19], v[152:155], v[48:51]
    ds_read_b128 v[180:183], v7 offset:14336
    v_fract_f32 v197, v197
    v_mfma_f32_16x16x32_bf16 v[52:55], a[20:23], v[152:155], v[52:55]
    s_waitcnt lgkmcnt(5)
    buffer_load_dwordx4 v13, s[48:51], s15 offen offset:2048 lds
    v_mfma_f32_16x16x32_bf16 v[56:59], a[16:19], v[156:159], v[56:59]
    v_exp_f32 v202, v202
    v_mfma_f32_16x16x32_bf16 v[60:63], a[20:23], v[156:159], v[60:63]
    buffer_load_dwordx4 v14, s[48:51], s15 offen offset:3072 lds
    v_mfma_f32_16x16x32_bf16 v[64:67], a[16:19], v[160:163], v[64:67]
    v_fract_f32 v203, v203
    v_exp_f32 v208, v208
    v_mfma_f32_16x16x32_bf16 v[68:71], a[20:23], v[160:163], v[68:71]
    v_fract_f32 v209, v209
    v_exp_f32 v214, v214
    s_waitcnt lgkmcnt(4)
    s_waitcnt lgkmcnt(0) vmcnt(9)
    s_barrier
    v_mfma_f32_16x16x32_bf16 v[32:35], a[24:27], v[164:167], v[32:35]
    ds_read_b128 a[32:35], v4 offset:8192
    s_add_u32 m0, s10, 40960
    s_add_u32 s15, s1, 512
    s_sub_u32 s31, s15, 1280
    s_min_u32 s15, s15, s31
    buffer_load_dwordx4 v15, s[52:55], s15 offen offset:0 lds
    v_mfma_f32_16x16x32_bf16 v[36:39], a[28:31], v[164:167], v[36:39]
    ds_read_b128 a[36:39], v4 offset:10240
    v_fract_f32 v215, v215
    v_mfma_f32_16x16x32_bf16 v[40:43], a[24:27], v[168:171], v[40:43]
    ds_read_b128 a[40:43], v5 offset:8192
    v_exp_f32 v220, v220
    v_mfma_f32_16x16x32_bf16 v[44:47], a[28:31], v[168:171], v[44:47]
    ds_read_b128 a[44:47], v5 offset:10240
    buffer_load_dwordx4 v16, s[52:55], s15 offen offset:1024 lds
    v_mfma_f32_16x16x32_bf16 v[48:51], a[24:27], v[172:175], v[48:51]
    ds_read_b128 v[144:147], v6 offset:20480
    v_fract_f32 v221, v221
    v_mfma_f32_16x16x32_bf16 v[52:55], a[28:31], v[172:175], v[52:55]
    ds_read_b128 v[148:151], v6 offset:21504
    v_cos_f32 v232, v197
    v_mfma_f32_16x16x32_bf16 v[56:59], a[24:27], v[176:179], v[56:59]
    ds_read_b128 v[152:155], v6 offset:22528
    buffer_load_dwordx4 v17, s[52:55], s15 offen offset:2048 lds
    v_mfma_f32_16x16x32_bf16 v[60:63], a[28:31], v[176:179], v[60:63]
    ds_read_b128 v[156:159], v6 offset:23552
    v_sin_f32 v233, v197
    v_mfma_f32_16x16x32_bf16 v[64:67], a[24:27], v[180:183], v[64:67]
    ds_read_b128 v[160:163], v6 offset:24576
    v_cos_f32 v234, v203
    v_mfma_f32_16x16x32_bf16 v[68:71], a[28:31], v[180:183], v[68:71]
    buffer_load_dwordx4 v18, s[52:55], s15 offen offset:3072 lds
    s_waitcnt lgkmcnt(4)
    v_mfma_f32_16x16x32_bf16 v[32:35], a[32:35], v[144:147], v[32:35]
    ds_read_b128 v[164:167], v7 offset:20480
    v_sin_f32 v235, v203
    v_mfma_f32_16x16x32_bf16 v[36:39], a[36:39], v[144:147], v[36:39]
    ds_read_b128 v[168:171], v7 offset:21504
    s_waitcnt lgkmcnt(4)
    v_cos_f32 v236, v209
    v_mfma_f32_16x16x32_bf16 v[40:43], a[32:35], v[148:151], v[40:43]
    ds_read_b128 v[172:175], v7 offset:22528
    s_add_u32 m0, s10, 45056
    s_nop 0
    buffer_load_dwordx4 v19, s[52:55], s15 offen lds
    v_mfma_f32_16x16x32_bf16 v[44:47], a[36:39], v[148:151], v[44:47]
    ds_read_b128 v[176:179], v7 offset:23552
    v_sin_f32 v237, v209
    v_mfma_f32_16x16x32_bf16 v[48:51], a[32:35], v[152:155], v[48:51]
    ds_read_b128 v[180:183], v7 offset:24576
    v_cos_f32 v238, v215
    v_mfma_f32_16x16x32_bf16 v[52:55], a[36:39], v[152:155], v[52:55]
    ds_read_b128 a[48:51], v4 offset:12288
    s_waitcnt lgkmcnt(6)
    s_add_u32 m0, s8, 8192
    s_add_u32 s15, s0, 768
    s_sub_u32 s31, s15, 1280
    s_min_u32 s15, s15, s31
    buffer_load_dwordx4 v11, s[48:51], s15 offen offset:0 lds
    v_mfma_f32_16x16x32_bf16 v[56:59], a[32:35], v[156:159], v[56:59]
    ds_read_b128 a[52:55], v4 offset:14336
    v_sin_f32 v239, v215
    v_mfma_f32_16x16x32_bf16 v[60:63], a[36:39], v[156:159], v[60:63]
    ds_read_b128 a[56:59], v5 offset:12288
    v_cos_f32 v240, v221
    v_mfma_f32_16x16x32_bf16 v[64:67], a[32:35], v[160:163], v[64:67]
    ds_read_b128 a[60:63], v5 offset:14336
    buffer_load_dwordx4 v12, s[48:51], s15 offen offset:1024 lds
    v_mfma_f32_16x16x32_bf16 v[68:71], a[36:39], v[160:163], v[68:71]
    v_sin_f32 v241, v221
    s_waitcnt lgkmcnt(8)
    v_mfma_f32_16x16x32_bf16 v[32:35], a[40:43], v[164:167], v[32:35]
    ds_read_b128 v[144:147], v6 offset:30720
    v_xor_b32 v193, v193, v30
    v_mfma_f32_16x16x32_bf16 v[36:39], a[44:47], v[164:167], v[36:39]
    ds_read_b128 v[148:151], v6 offset:31744
    s_waitcnt lgkmcnt(8)
    buffer_load_dwordx4 v13, s[48:51], s15 offen offset:2048 lds
    v_mfma_f32_16x16x32_bf16 v[40:43], a[40:43], v[168:171], v[40:43]
    ds_read_b128 v[152:155], v6 offset:32768
    v_xor_b32 v194, v194, v30
    v_mfma_f32_16x16x32_bf16 v[44:47], a[44:47], v[168:171], v[44:47]
    ds_read_b128 v[156:159], v6 offset:33792
    v_xor_b32 v199, v199, v30
    v_mfma_f32_16x16x32_bf16 v[48:51], a[40:43], v[172:175], v[48:51]
    ds_read_b128 v[160:163], v6 offset:34816
    buffer_load_dwordx4 v14, s[48:51], s15 offen offset:3072 lds
    v_mfma_f32_16x16x32_bf16 v[52:55], a[44:47], v[172:175], v[52:55]
    s_waitcnt lgkmcnt(9)
    v_xor_b32 v200, v200, v30
    v_xor_b32 v205, v205, v30
    v_mfma_f32_16x16x32_bf16 v[56:59], a[40:43], v[176:179], v[56:59]
    v_xor_b32 v206, v206, v30
    v_xor_b32 v211, v211, v30
    v_mfma_f32_16x16x32_bf16 v[60:63], a[44:47], v[176:179], v[60:63]
    s_waitcnt lgkmcnt(5)
    s_add_u32 m0, s8, 12288
    s_add_u32 s15, s0, 896
    s_sub_u32 s31, s15, 1280
    s_min_u32 s15, s15, s31
    buffer_load_dwordx4 v11, s[48:51], s15 offen offset:0 lds
    v_mfma_f32_16x16x32_bf16 v[64:67], a[40:43], v[180:183], v[64:67]
    v_xor_b32 v212, v212, v30
    v_xor_b32 v217, v217, v30
    v_mfma_f32_16x16x32_bf16 v[68:71], a[44:47], v[180:183], v[68:71]
    v_xor_b32 v218, v218, v30
    v_mul_f32 v232, v232, v196
    s_waitcnt lgkmcnt(4)
    v_mfma_f32_16x16x32_bf16 v[32:35], a[48:51], v[144:147], v[32:35]
    ds_read_b128 v[164:167], v7 offset:30720
    buffer_load_dwordx4 v12, s[48:51], s15 offen offset:1024 lds
    v_mfma_f32_16x16x32_bf16 v[36:39], a[52:55], v[144:147], v[36:39]
    ds_read_b128 v[168:171], v7 offset:31744
    s_waitcnt lgkmcnt(4)
    v_mul_f32 v233, v233, v196
    v_mfma_f32_16x16x32_bf16 v[40:43], a[48:51], v[148:151], v[40:43]
    ds_read_b128 v[172:175], v7 offset:32768
    v_mul_f32 v234, v234, v202
    v_mfma_f32_16x16x32_bf16 v[44:47], a[52:55], v[148:151], v[44:47]
    ds_read_b128 v[176:179], v7 offset:33792
    buffer_load_dwordx4 v13, s[48:51], s15 offen offset:2048 lds
    v_mfma_f32_16x16x32_bf16 v[48:51], a[48:51], v[152:155], v[48:51]
    ds_read_b128 v[180:183], v7 offset:34816
    v_mul_f32 v235, v235, v202
    v_mfma_f32_16x16x32_bf16 v[52:55], a[52:55], v[152:155], v[52:55]
    s_waitcnt lgkmcnt(5)
    v_mul_f32 v236, v236, v208
    v_mul_f32 v237, v237, v208
    v_mfma_f32_16x16x32_bf16 v[56:59], a[48:51], v[156:159], v[56:59]
    buffer_load_dwordx4 v14, s[48:51], s15 offen offset:3072 lds
    v_mfma_f32_16x16x32_bf16 v[60:63], a[52:55], v[156:159], v[60:63]
    v_mul_f32 v238, v238, v214
    v_mul_f32 v239, v239, v214
    v_mfma_f32_16x16x32_bf16 v[64:67], a[48:51], v[160:163], v[64:67]
    v_mul_f32 v240, v240, v220
    v_mul_f32 v241, v241, v220
    v_mfma_f32_16x16x32_bf16 v[68:71], a[52:55], v[160:163], v[68:71]
    v_mul_f32 v196, v194, v232
    v_mul_f32 v197, v195, v232
    s_waitcnt lgkmcnt(4)
    s_waitcnt lgkmcnt(0) vmcnt(8)
    s_barrier
    v_mfma_f32_16x16x32_bf16 v[32:35], a[56:59], v[164:167], v[32:35]
    ds_read_b128 a[64:67], v4 offset:0
    s_add_u32 m0, s10, 61440
    s_add_u32 s15, s1, 768
    s_sub_u32 s31, s15, 1280
    s_min_u32 s15, s15, s31
    buffer_load_dwordx4 v15, s[52:55], s15 offen offset:0 lds
    v_mfma_f32_16x16x32_bf16 v[36:39], a[60:63], v[164:167], v[36:39]
    ds_read_b128 a[68:71], v4 offset:2048
    v_mul_f32 v202, v200, v234
    v_mfma_f32_16x16x32_bf16 v[40:43], a[56:59], v[168:171], v[40:43]
    ds_read_b128 a[72:75], v5 offset:0
    v_mul_f32 v203, v201, v234
    v_mfma_f32_16x16x32_bf16 v[44:47], a[60:63], v[168:171], v[44:47]
    ds_read_b128 a[76:79], v5 offset:2048
    buffer_load_dwordx4 v16, s[52:55], s15 offen offset:1024 lds
    v_mfma_f32_16x16x32_bf16 v[48:51], a[56:59], v[172:175], v[48:51]
    ds_read_b128 v[144:147], v8 offset:0
    v_mul_f32 v208, v206, v236
    v_mfma_f32_16x16x32_bf16 v[52:55], a[60:63], v[172:175], v[52:55]
    ds_read_b128 v[148:151], v8 offset:1024
    v_mul_f32 v209, v207, v236
    v_mfma_f32_16x16x32_bf16 v[56:59], a[56:59], v[176:179], v[56:59]
    ds_read_b128 v[152:155], v8 offset:2048
    buffer_load_dwordx4 v17, s[52:55], s15 offen offset:2048 lds
    v_mfma_f32_16x16x32_bf16 v[60:63], a[60:63], v[176:179], v[60:63]
    ds_read_b128 v[156:159], v8 offset:3072
    v_mul_f32 v214, v212, v238
    v_mfma_f32_16x16x32_bf16 v[64:67], a[56:59], v[180:183], v[64:67]
    ds_read_b128 v[160:163], v8 offset:4096
    v_mul_f32 v215, v213, v238
    v_mfma_f32_16x16x32_bf16 v[68:71], a[60:63], v[180:183], v[68:71]
    buffer_load_dwordx4 v18, s[52:55], s15 offen offset:3072 lds
    s_waitcnt lgkmcnt(4)
    v_mfma_f32_16x16x32_bf16 v[32:35], a[64:67], v[144:147], v[32:35]
    ds_read_b128 v[164:167], v9 offset:0
    v_mul_f32 v220, v218, v240
    v_mfma_f32_16x16x32_bf16 v[36:39], a[68:71], v[144:147], v[36:39]
    ds_read_b128 v[168:171], v9 offset:1024
    s_waitcnt lgkmcnt(4)
    v_mul_f32 v221, v219, v240
    v_mfma_f32_16x16x32_bf16 v[40:43], a[64:67], v[148:151], v[40:43]
    ds_read_b128 v[172:175], v9 offset:2048
    s_add_u32 m0, s10, 65536
    s_nop 0
    buffer_load_dwordx4 v19, s[52:55], s15 offen lds
    v_mfma_f32_16x16x32_bf16 v[44:47], a[68:71], v[148:151], v[44:47]
    ds_read_b128 v[176:179], v9 offset:3072
    v_fmac_f32 v196, v195, v233
    v_mfma_f32_16x16x32_bf16 v[48:51], a[64:67], v[152:155], v[48:51]
    ds_read_b128 v[180:183], v9 offset:4096
    v_fma_f32 v197, -v194, v233, v197
    v_mfma_f32_16x16x32_bf16 v[52:55], a[68:71], v[152:155], v[52:55]
    ds_read_b128 a[80:83], v4 offset:4096
    s_waitcnt lgkmcnt(6)
    s_add_u32 m0, s8, 0
    s_add_u32 s15, s0, 1024
    s_sub_u32 s31, s15, 1280
    s_min_u32 s15, s15, s31
    buffer_load_dwordx4 v11, s[48:51], s15 offen offset:0 lds
    v_mfma_f32_16x16x32_bf16 v[56:59], a[64:67], v[156:159], v[56:59]
    ds_read_b128 a[84:87], v4 offset:6144
    v_fmac_f32 v202, v201, v235
    v_mfma_f32_16x16x32_bf16 v[60:63], a[68:71], v[156:159], v[60:63]
    ds_read_b128 a[88:91], v5 offset:4096
    v_fma_f32 v203, -v200, v235, v203
    v_mfma_f32_16x16x32_bf16 v[64:67], a[64:67], v[160:163], v[64:67]
    ds_read_b128 a[92:95], v5 offset:6144
    buffer_load_dwordx4 v12, s[48:51], s15 offen offset:1024 lds
    v_mfma_f32_16x16x32_bf16 v[68:71], a[68:71], v[160:163], v[68:71]
    v_fmac_f32 v208, v207, v237
    v_fma_f32 v209, -v206, v237, v209
    s_waitcnt lgkmcnt(8)
    v_mfma_f32_16x16x32_bf16 v[32:35], a[72:75], v[164:167], v[32:35]
    ds_read_b128 v[144:147], v8 offset:10240
    v_fmac_f32 v214, v213, v239
    v_mfma_f32_16x16x32_bf16 v[36:39], a[76:79], v[164:167], v[36:39]
    ds_read_b128 v[148:151], v8 offset:11264
    s_waitcnt lgkmcnt(8)
    buffer_load_dwordx4 v13, s[48:51], s15 offen offset:2048 lds
    v_mfma_f32_16x16x32_bf16 v[40:43], a[72:75], v[168:171], v[40:43]
    ds_read_b128 v[152:155], v8 offset:12288
    v_fma_f32 v215, -v212, v239, v215
    v_mfma_f32_16x16x32_bf16 v[44:47], a[76:79], v[168:171], v[44:47]
    ds_read_b128 v[156:159], v8 offset:13312
    v_fmac_f32 v220, v219, v241
    v_mfma_f32_16x16x32_bf16 v[48:51], a[72:75], v[172:175], v[48:51]
    ds_read_b128 v[160:163], v8 offset:14336
    buffer_load_dwordx4 v14, s[48:51], s15 offen offset:3072 lds
    v_mfma_f32_16x16x32_bf16 v[52:55], a[76:79], v[172:175], v[52:55]
    s_waitcnt lgkmcnt(9)
    v_fma_f32 v221, -v218, v241, v221
    v_xor_b32 v23, v23, v30
    v_mfma_f32_16x16x32_bf16 v[56:59], a[72:75], v[176:179], v[56:59]
    v_xor_b32 v25, v25, v30
    v_mfma_f32_16x16x32_bf16 v[60:63], a[76:79], v[176:179], v[60:63]
    s_waitcnt lgkmcnt(5)
    s_add_u32 m0, s8, 4096
    s_add_u32 s15, s0, 1152
    s_sub_u32 s31, s15, 1280
    s_min_u32 s15, s15, s31
    buffer_load_dwordx4 v11, s[48:51], s15 offen offset:0 lds
    v_mfma_f32_16x16x32_bf16 v[64:67], a[72:75], v[180:183], v[64:67]
    v_mfma_f32_16x16x32_bf16 v[68:71], a[76:79], v[180:183], v[68:71]
    s_waitcnt lgkmcnt(4)
    v_mfma_f32_16x16x32_bf16 v[32:35], a[80:83], v[144:147], v[32:35]
    ds_read_b128 v[164:167], v9 offset:10240
    buffer_load_dwordx4 v12, s[48:51], s15 offen offset:1024 lds
    v_mfma_f32_16x16x32_bf16 v[36:39], a[84:87], v[144:147], v[36:39]
    ds_read_b128 v[168:171], v9 offset:11264
    s_waitcnt lgkmcnt(4)
    v_mfma_f32_16x16x32_bf16 v[40:43], a[80:83], v[148:151], v[40:43]
    ds_read_b128 v[172:175], v9 offset:12288
    v_mfma_f32_16x16x32_bf16 v[44:47], a[84:87], v[148:151], v[44:47]
    ds_read_b128 v[176:179], v9 offset:13312
    buffer_load_dwordx4 v13, s[48:51], s15 offen offset:2048 lds
    v_mfma_f32_16x16x32_bf16 v[48:51], a[80:83], v[152:155], v[48:51]
    ds_read_b128 v[180:183], v9 offset:14336
    v_mfma_f32_16x16x32_bf16 v[52:55], a[84:87], v[152:155], v[52:55]
    s_waitcnt lgkmcnt(5)
    v_mfma_f32_16x16x32_bf16 v[56:59], a[80:83], v[156:159], v[56:59]
    buffer_load_dwordx4 v14, s[48:51], s15 offen offset:3072 lds
    v_mfma_f32_16x16x32_bf16 v[60:63], a[84:87], v[156:159], v[60:63]
    v_mfma_f32_16x16x32_bf16 v[64:67], a[80:83], v[160:163], v[64:67]
    v_mfma_f32_16x16x32_bf16 v[68:71], a[84:87], v[160:163], v[68:71]
    s_waitcnt lgkmcnt(4)
    s_waitcnt lgkmcnt(0) vmcnt(8)
    s_barrier
    v_mfma_f32_16x16x32_bf16 v[32:35], a[88:91], v[164:167], v[32:35]
    ds_read_b128 a[96:99], v4 offset:8192
    s_add_u32 m0, s10, 0
    s_add_u32 s15, s1, 1024
    s_sub_u32 s31, s15, 1280
    s_min_u32 s15, s15, s31
    buffer_load_dwordx4 v15, s[52:55], s15 offen offset:0 lds
    v_mfma_f32_16x16x32_bf16 v[36:39], a[92:95], v[164:167], v[36:39]
    ds_read_b128 a[100:103], v4 offset:10240
    v_mfma_f32_16x16x32_bf16 v[40:43], a[88:91], v[168:171], v[40:43]
    ds_read_b128 a[104:107], v5 offset:8192
    buffer_load_dwordx4 v16, s[52:55], s15 offen offset:1024 lds
    v_mfma_f32_16x16x32_bf16 v[44:47], a[92:95], v[168:171], v[44:47]
    ds_read_b128 a[108:111], v5 offset:10240
    v_mfma_f32_16x16x32_bf16 v[48:51], a[88:91], v[172:175], v[48:51]
    ds_read_b128 v[144:147], v8 offset:20480
    v_mfma_f32_16x16x32_bf16 v[52:55], a[92:95], v[172:175], v[52:55]
    ds_read_b128 v[148:151], v8 offset:21504
    buffer_load_dwordx4 v17, s[52:55], s15 offen offset:2048 lds
    v_mfma_f32_16x16x32_bf16 v[56:59], a[88:91], v[176:179], v[56:59]
    ds_read_b128 v[152:155], v8 offset:22528
    v_mfma_f32_16x16x32_bf16 v[60:63], a[92:95], v[176:179], v[60:63]
    ds_read_b128 v[156:159], v8 offset:23552
    v_mfma_f32_16x16x32_bf16 v[64:67], a[88:91], v[180:183], v[64:67]
    ds_read_b128 v[160:163], v8 offset:24576
    buffer_load_dwordx4 v18, s[52:55], s15 offen offset:3072 lds
    v_mfma_f32_16x16x32_bf16 v[68:71], a[92:95], v[180:183], v[68:71]
    s_waitcnt lgkmcnt(4)
    v_mfma_f32_16x16x32_bf16 v[32:35], a[96:99], v[144:147], v[32:35]
    ds_read_b128 v[164:167], v9 offset:20480
    v_mfma_f32_16x16x32_bf16 v[36:39], a[100:103], v[144:147], v[36:39]
    ds_read_b128 v[168:171], v9 offset:21504
    s_waitcnt lgkmcnt(4)
    s_add_u32 m0, s10, 4096
    s_nop 0
    buffer_load_dwordx4 v19, s[52:55], s15 offen lds
    v_mfma_f32_16x16x32_bf16 v[40:43], a[96:99], v[148:151], v[40:43]
    ds_read_b128 v[172:175], v9 offset:22528
    v_mfma_f32_16x16x32_bf16 v[44:47], a[100:103], v[148:151], v[44:47]
    ds_read_b128 v[176:179], v9 offset:23552
    v_mfma_f32_16x16x32_bf16 v[48:51], a[96:99], v[152:155], v[48:51]
    ds_read_b128 v[180:183], v9 offset:24576
    s_cmp_eq_u32 s3, 0
    s_cbranch_scc0 L_skip_5
    buffer_load_dword v26, v72, s[64:67], 0 offen sc1
L_skip_5:
    v_mfma_f32_16x16x32_bf16 v[52:55], a[100:103], v[152:155], v[52:55]
    ds_read_b128 a[112:115], v4 offset:12288
    s_waitcnt lgkmcnt(6)
    v_mfma_f32_16x16x32_bf16 v[56:59], a[96:99], v[156:159], v[56:59]
    ds_read_b128 a[116:119], v4 offset:14336
    v_mfma_f32_16x16x32_bf16 v[60:63], a[100:103], v[156:159], v[60:63]
    ds_read_b128 a[120:123], v5 offset:12288
    s_mov_b32 m0, s87
    s_nop 0
    buffer_load_dwordx4 v73, s[56:59], 0 offen lds
    v_mfma_f32_16x16x32_bf16 v[64:67], a[96:99], v[160:163], v[64:67]
    ds_read_b128 a[124:127], v5 offset:14336
    v_mfma_f32_16x16x32_bf16 v[68:71], a[100:103], v[160:163], v[68:71]
    s_waitcnt lgkmcnt(8)
    v_mfma_f32_16x16x32_bf16 v[32:35], a[104:107], v[164:167], v[32:35]
    ds_read_b128 v[144:147], v8 offset:30720
    s_lshr_b32 s12, s3, 1
    v_mfma_f32_16x16x32_bf16 v[36:39], a[108:111], v[164:167], v[36:39]
    ds_read_b128 v[148:151], v8 offset:31744
    s_waitcnt lgkmcnt(8)
    s_lshl_b32 s12, s12, 5
    v_mfma_f32_16x16x32_bf16 v[40:43], a[104:107], v[168:171], v[40:43]
    ds_read_b128 v[152:155], v8 offset:32768
    s_lshl_b32 s13, s88, 2
    v_mfma_f32_16x16x32_bf16 v[44:47], a[108:111], v[168:171], v[44:47]
    ds_read_b128 v[156:159], v8 offset:33792
    s_add_u32 s12, s12, s13
    v_mfma_f32_16x16x32_bf16 v[48:51], a[104:107], v[172:175], v[48:51]
    ds_read_b128 v[160:163], v8 offset:34816
    v_lshl_add_u32 v29, v3, 3, s12
    v_mfma_f32_16x16x32_bf16 v[52:55], a[108:111], v[172:175], v[52:55]
    s_waitcnt lgkmcnt(9)
    v_mul_u32_u24 v11, 2560, v29
    v_lshl_add_u32 v11, v2, 2, v11
    v_mfma_f32_16x16x32_bf16 v[56:59], a[104:107], v[176:179], v[56:59]
    v_add_u32 v12, 5120, v11
    s_lshl_b32 s13, s7, 6
    v_mfma_f32_16x16x32_bf16 v[60:63], a[108:111], v[176:179], v[60:63]
    s_add_u32 s12, s12, s13
    s_lshl_b32 s86, s12, 2
    s_add_u32 s86, s86, 151552
    v_mfma_f32_16x16x32_bf16 v[64:67], a[104:107], v[180:183], v[64:67]
    s_mul_i32 s12, s12, 1280
    s_mul_i32 s13, s6, 160
    s_add_u32 s12, s12, s13
    v_mfma_f32_16x16x32_bf16 v[68:71], a[108:111], v[180:183], v[68:71]
    v_add_u32 v29, 0, v1
    v_mul_u32_u24 v30, 6554, v29
    s_waitcnt lgkmcnt(4)
    v_mfma_f32_16x16x32_bf16 v[32:35], a[112:115], v[144:147], v[32:35]
    ds_read_b128 v[164:167], v9 offset:30720
    v_lshrrev_b32 v30, 16, v30
    v_mfma_f32_16x16x32_bf16 v[36:39], a[116:119], v[144:147], v[36:39]
    ds_read_b128 v[168:171], v9 offset:31744
    s_waitcnt lgkmcnt(4)
    v_mul_u32_u24 v31, 10, v30
    v_mfma_f32_16x16x32_bf16 v[40:43], a[112:115], v[148:151], v[40:43]
    ds_read_b128 v[172:175], v9 offset:32768
    v_sub_u32 v29, v29, v31
    v_mfma_f32_16x16x32_bf16 v[44:47], a[116:119], v[148:151], v[44:47]
    ds_read_b128 v[176:179], v9 offset:33792
    v_and_b32 v31, 28, v30
    v_mfma_f32_16x16x32_bf16 v[48:51], a[112:115], v[152:155], v[48:51]
    ds_read_b128 v[180:183], v9 offset:34816
    v_add_u32 v30, v30, v31
    v_mfma_f32_16x16x32_bf16 v[52:55], a[116:119], v[152:155], v[52:55]
    s_waitcnt lgkmcnt(5)
    v_mul_u32_u24 v30, 1280, v30
    v_lshl_add_u32 v30, v29, 4, v30
    v_mfma_f32_16x16x32_bf16 v[56:59], a[112:115], v[156:159], v[56:59]
    v_add_u32 v13, s12, v30
    s_sub_u32 s12, s12, 1024
    v_mfma_f32_16x16x32_bf16 v[60:63], a[116:119], v[156:159], v[60:63]
    v_add_u32 v29, 64, v1
    v_mul_u32_u24 v30, 6554, v29
    v_mfma_f32_16x16x32_bf16 v[64:67], a[112:115], v[160:163], v[64:67]
    v_lshrrev_b32 v30, 16, v30
    v_mul_u32_u24 v31, 10, v30
    v_mfma_f32_16x16x32_bf16 v[68:71], a[116:119], v[160:163], v[68:71]
    v_sub_u32 v29, v29, v31
    v_and_b32 v31, 28, v30
    s_waitcnt lgkmcnt(4)
    s_waitcnt lgkmcnt(0)
    s_cmp_eq_u32 s3, 0
    s_cbranch_scc0 L_skip_8
    s_waitcnt vmcnt(1)
    v_cmp_gt_u32 vcc, 20, v26
    s_nop 0
    s_cbranch_vccnz L_slow_6
L_back_7:
L_skip_8:
    s_waitcnt vmcnt(1)
    s_barrier
    v_mfma_f32_16x16x32_bf16 v[32:35], a[120:123], v[164:167], v[32:35]
    ds_read_b128 a[128:131], v4 offset:0
    v_add_u32 v30, v30, v31
    s_add_u32 m0, s9, 20480
    s_add_u32 s15, s2, 0
    s_sub_u32 s31, s15, 102400
    s_min_u32 s15, s15, s31
    s_add_u32 s15, s15, s16
    buffer_load_dwordx4 v20, s[64:67], s15 offen offset:0 sc1 lds
    v_mfma_f32_16x16x32_bf16 v[36:39], a[124:127], v[164:167], v[36:39]
    ds_read_b128 a[132:135], v4 offset:2048
    v_mul_u32_u24 v30, 1280, v30
    v_mfma_f32_16x16x32_bf16 v[40:43], a[120:123], v[168:171], v[40:43]
    ds_read_b128 a[136:139], v5 offset:0
    v_lshl_add_u32 v30, v29, 4, v30
    buffer_load_dwordx4 v20, s[64:67], s15 offen offset:1024 sc1 lds
    v_mfma_f32_16x16x32_bf16 v[44:47], a[124:127], v[168:171], v[44:47]
    ds_read_b128 a[140:143], v5 offset:2048
    v_add_u32 v14, s12, v30
    v_mfma_f32_16x16x32_bf16 v[48:51], a[120:123], v[172:175], v[48:51]
    ds_read_b128 v[144:147], v6 offset:0
    s_sub_u32 s12, s12, 1024
    v_mfma_f32_16x16x32_bf16 v[52:55], a[124:127], v[172:175], v[52:55]
    ds_read_b128 v[148:151], v6 offset:1024
    v_add_u32 v29, 128, v1
    buffer_load_dwordx4 v20, s[64:67], s15 offen offset:2048 sc1 lds
    v_mfma_f32_16x16x32_bf16 v[56:59], a[120:123], v[176:179], v[56:59]
    ds_read_b128 v[152:155], v6 offset:2048
    v_mul_u32_u24 v30, 6554, v29
    v_mfma_f32_16x16x32_bf16 v[60:63], a[124:127], v[176:179], v[60:63]
    ds_read_b128 v[156:159], v6 offset:3072
    v_lshrrev_b32 v30, 16, v30
    v_mfma_f32_16x16x32_bf16 v[64:67], a[120:123], v[180:183], v[64:67]
    ds_read_b128 v[160:163], v6 offset:4096
    v_mul_u32_u24 v31, 10, v30
    buffer_load_dwordx4 v20, s[64:67], s15 offen offset:3072 sc1 lds
    v_mfma_f32_16x16x32_bf16 v[68:71], a[124:127], v[180:183], v[68:71]
    v_sub_u32 v29, v29, v31
    v_and_b32 v31, 28, v30
    s_waitcnt lgkmcnt(4)
    v_mfma_f32_16x16x32_bf16 v[32:35], a[128:131], v[144:147], v[32:35]
    ds_read_b128 v[164:167], v7 offset:0
    v_add_u32 v30, v30, v31
    v_mfma_f32_16x16x32_bf16 v[36:39], a[132:135], v[144:147], v[36:39]
    ds_read_b128 v[168:171], v7 offset:1024
    s_waitcnt lgkmcnt(4)
    v_mul_u32_u24 v30, 1280, v30
    s_add_u32 m0, s9, 24576
    s_add_u32 s15, s15, 4096
    buffer_load_dwordx4 v20, s[64:67], s15 offen sc1 lds
    v_mfma_f32_16x16x32_bf16 v[40:43], a[128:131], v[148:151], v[40:43]
    ds_read_b128 v[172:175], v7 offset:2048
    v_lshl_add_u32 v30, v29, 4, v30
    v_mfma_f32_16x16x32_bf16 v[44:47], a[132:135], v[148:151], v[44:47]
    ds_read_b128 v[176:179], v7 offset:3072
    v_add_u32 v19, s12, v30
    v_mfma_f32_16x16x32_bf16 v[48:51], a[128:131], v[152:155], v[48:51]
    ds_read_b128 v[180:183], v7 offset:4096
    v_add_u32 v15, s8, v20
    s_add_u32 m0, s9, 40960
    s_add_u32 s15, s2, 20480
    s_sub_u32 s31, s15, 102400
    s_min_u32 s15, s15, s31
    s_add_u32 s15, s15, s16
    buffer_load_dwordx4 v20, s[64:67], s15 offen offset:0 sc1 lds
    v_mfma_f32_16x16x32_bf16 v[52:55], a[132:135], v[152:155], v[52:55]
    ds_read_b128 a[144:147], v4 offset:4096
    s_waitcnt lgkmcnt(6)
    s_sub_u32 s12, s3, 1
    v_mfma_f32_16x16x32_bf16 v[56:59], a[128:131], v[156:159], v[56:59]
    ds_read_b128 a[148:151], v4 offset:6144
    s_and_b32 s12, s12, 3
    buffer_load_dwordx4 v20, s[64:67], s15 offen offset:1024 sc1 lds
    v_mfma_f32_16x16x32_bf16 v[60:63], a[132:135], v[156:159], v[60:63]
    ds_read_b128 a[152:155], v5 offset:4096
    s_mul_i32 s12, s12, 17408
    v_mfma_f32_16x16x32_bf16 v[64:67], a[128:131], v[160:163], v[64:67]
    ds_read_b128 a[156:159], v5 offset:6144
    s_add_u32 s12, s12, 81920
    v_mfma_f32_16x16x32_bf16 v[68:71], a[132:135], v[160:163], v[68:71]
    v_add_u32 v16, s12, v20
    s_sub_u32 s12, s3, 2
    buffer_load_dwordx4 v20, s[64:67], s15 offen offset:2048 sc1 lds
    s_waitcnt lgkmcnt(8)
    v_mfma_f32_16x16x32_bf16 v[32:35], a[136:139], v[164:167], v[32:35]
    ds_read_b128 v[144:147], v6 offset:10240
    s_and_b32 s12, s12, 3
    v_mfma_f32_16x16x32_bf16 v[36:39], a[140:143], v[164:167], v[36:39]
    ds_read_b128 v[148:151], v6 offset:11264
    s_waitcnt lgkmcnt(8)
    s_mul_i32 s12, s12, 17408
    v_mfma_f32_16x16x32_bf16 v[40:43], a[136:139], v[168:171], v[40:43]
    ds_read_b128 v[152:155], v6 offset:12288
    s_add_u32 s12, s12, 81920
    buffer_load_dwordx4 v20, s[64:67], s15 offen offset:3072 sc1 lds
    v_mfma_f32_16x16x32_bf16 v[44:47], a[140:143], v[168:171], v[44:47]
    ds_read_b128 v[156:159], v6 offset:13312
    v_add_u32 v17, s12, v20
    v_mfma_f32_16x16x32_bf16 v[48:51], a[136:139], v[172:175], v[48:51]
    ds_read_b128 v[160:163], v6 offset:14336
    s_sub_u32 s12, s3, 3
    v_mfma_f32_16x16x32_bf16 v[52:55], a[140:143], v[172:175], v[52:55]
    s_waitcnt lgkmcnt(9)
    s_and_b32 s12, s12, 3
    s_mul_i32 s12, s12, 17408
    s_add_u32 s12, s12, 81920
    s_add_u32 m0, s9, 45056
    s_add_u32 s15, s15, 4096
    buffer_load_dwordx4 v20, s[64:67], s15 offen sc1 lds
    v_mfma_f32_16x16x32_bf16 v[56:59], a[136:139], v[176:179], v[56:59]
    v_add_u32 v18, s12, v20
    v_lshrrev_b32 v29, 2, v1
    v_mfma_f32_16x16x32_bf16 v[60:63], a[140:143], v[176:179], v[60:63]
    v_mul_u32_u24 v29, 160, v29
    v_and_b32 v30, 3, v1
    s_add_u32 m0, s9, 61440
    s_add_u32 s15, s2, 40960
    s_sub_u32 s31, s15, 102400
    s_min_u32 s15, s15, s31
    s_add_u32 s15, s15, s16
    buffer_load_dwordx4 v20, s[64:67], s15 offen offset:0 sc1 lds
    v_mfma_f32_16x16x32_bf16 v[64:67], a[136:139], v[180:183], v[64:67]
    v_lshl_add_u32 v29, v30, 3, v29
    v_add_u32 v230, s8, v29
    v_mfma_f32_16x16x32_bf16 v[68:71], a[140:143], v[180:183], v[68:71]
    v_lshlrev_b32 v231, 1, v2
    v_add_u32 v231, 160512, v231
    buffer_load_dwordx4 v20, s[64:67], s15 offen offset:1024 sc1 lds
    s_waitcnt lgkmcnt(4)
    v_mfma_f32_16x16x32_bf16 v[32:35], a[144:147], v[144:147], v[32:35]
    ds_read_b128 v[164:167], v7 offset:10240
    v_mfma_f32_16x16x32_bf16 v[36:39], a[148:151], v[144:147], v[36:39]
    ds_read_b128 v[168:171], v7 offset:11264
    s_waitcnt lgkmcnt(4)
    v_mfma_f32_16x16x32_bf16 v[40:43], a[144:147], v[148:151], v[40:43]
    ds_read_b128 v[172:175], v7 offset:12288
    buffer_load_dwordx4 v20, s[64:67], s15 offen offset:2048 sc1 lds
    v_mfma_f32_16x16x32_bf16 v[44:47], a[148:151], v[148:151], v[44:47]
    ds_read_b128 v[176:179], v7 offset:13312
    v_mfma_f32_16x16x32_bf16 v[48:51], a[144:147], v[152:155], v[48:51]
    ds_read_b128 v[180:183], v7 offset:14336
    v_mfma_f32_16x16x32_bf16 v[52:55], a[148:151], v[152:155], v[52:55]
    s_waitcnt lgkmcnt(5)
    v_mfma_f32_16x16x32_bf16 v[56:59], a[144:147], v[156:159], v[56:59]
    buffer_load_dwordx4 v20, s[64:67], s15 offen offset:3072 sc1 lds
    v_mfma_f32_16x16x32_bf16 v[60:63], a[148:151], v[156:159], v[60:63]
    v_mfma_f32_16x16x32_bf16 v[64:67], a[144:147], v[160:163], v[64:67]
    v_mfma_f32_16x16x32_bf16 v[68:71], a[148:151], v[160:163], v[68:71]
    s_waitcnt lgkmcnt(4)
    s_waitcnt lgkmcnt(0) vmcnt(9)
    s_barrier
    v_mul_u32_u24 v6, 1280, v3
    v_lshl_add_u32 v6, v2, 4, v6
    v_and_b32 v28, 8, v2
    v_lshl_add_u32 v7, v28, 6, v6
    v_add_u32 v7, 256, v7
    v_add_u32 v8, 40960, v6
    v_add_u32 v9, 40960, v7
    v_mfma_f32_16x16x32_bf16 v[32:35], a[152:155], v[164:167], v[32:35]
    ds_read_b128 v[144:147], v6 offset:20480
    s_add_u32 m0, s9, 65536
    s_add_u32 s15, s15, 4096
    buffer_load_dwordx4 v20, s[64:67], s15 offen sc1 lds
    v_mfma_f32_16x16x32_bf16 v[36:39], a[156:159], v[164:167], v[36:39]
    ds_read_b128 v[148:151], v6 offset:20864
    v_mfma_f32_16x16x32_bf16 v[40:43], a[152:155], v[168:171], v[40:43]
    ds_read_b128 v[152:155], v7 offset:20480
    v_mfma_f32_16x16x32_bf16 v[44:47], a[156:159], v[168:171], v[44:47]
    ds_read_b128 v[156:159], v6 offset:21120
    s_add_u32 m0, s9, 0
    s_add_u32 s15, s2, 61440
    s_sub_u32 s31, s15, 102400
    s_min_u32 s15, s15, s31
    s_add_u32 s15, s15, s16
    buffer_load_dwordx4 v20, s[64:67], s15 offen offset:0 sc1 lds
    v_mfma_f32_16x16x32_bf16 v[48:51], a[152:155], v[172:175], v[48:51]
    ds_read_b128 v[160:163], v6 offset:21504
    v_mfma_f32_16x16x32_bf16 v[52:55], a[156:159], v[172:175], v[52:55]
    buffer_load_dwordx4 v20, s[64:67], s15 offen offset:1024 sc1 lds
    v_mfma_f32_16x16x32_bf16 v[56:59], a[152:155], v[176:179], v[56:59]
    v_mfma_f32_16x16x32_bf16 v[60:63], a[156:159], v[176:179], v[60:63]
    v_mfma_f32_16x16x32_bf16 v[64:67], a[152:155], v[180:183], v[64:67]
    v_mfma_f32_16x16x32_bf16 v[68:71], a[156:159], v[180:183], v[68:71]
    buffer_load_dwordx4 v20, s[64:67], s15 offen offset:2048 sc1 lds
    s_waitcnt lgkmcnt(4)
    v_mfma_f32_16x16x32_bf16 v[80:83], a[0:3], v[144:147], v[222:225]
    ds_read_b128 v[164:167], v6 offset:25600
    v_fma_f32 v237, v192, v32, v33
    v_fma_f32 v238, v198, v40, v41
    v_mfma_f32_16x16x32_bf16 v[84:87], a[4:7], v[144:147], v[222:225]
    ds_read_b128 v[168:171], v6 offset:25984
    s_waitcnt lgkmcnt(4)
    v_fma_f32 v239, v204, v48, v49
    v_fma_f32 v240, v210, v56, v57
    v_mfma_f32_16x16x32_bf16 v[88:91], a[0:3], v[148:151], v[222:225]
    ds_read_b128 v[172:175], v7 offset:25600
    v_fma_f32 v241, v216, v64, v65
    v_fmac_f32_dpp v237, -v32, v193 row_ror:8 row_mask:0xf bank_mask:0xf
    buffer_load_dwordx4 v20, s[64:67], s15 offen offset:3072 sc1 lds
    v_mfma_f32_16x16x32_bf16 v[92:95], a[4:7], v[148:151], v[222:225]
    ds_read_b128 v[176:179], v6 offset:26240
    v_fmac_f32_dpp v238, -v40, v199 row_ror:8 row_mask:0xf bank_mask:0xf
    v_fmac_f32_dpp v239, -v48, v205 row_ror:8 row_mask:0xf bank_mask:0xf
    v_mfma_f32_16x16x32_bf16 v[96:99], a[0:3], v[152:155], v[226:229]
    ds_read_b128 v[180:183], v6 offset:26624
    v_fmac_f32_dpp v240, -v56, v211 row_ror:8 row_mask:0xf bank_mask:0xf
    v_fmac_f32_dpp v241, -v64, v217 row_ror:8 row_mask:0xf bank_mask:0xf
    v_mfma_f32_16x16x32_bf16 v[100:103], a[4:7], v[152:155], v[226:229]
    s_waitcnt lgkmcnt(5)
    v_fma_f32 v232, v192, v237, v34
    v_fma_f32 v233, v198, v238, v42
    v_fma_f32 v234, v204, v239, v50
    s_add_u32 m0, s9, 4096
    s_add_u32 s15, s15, 4096
    buffer_load_dwordx4 v20, s[64:67], s15 offen sc1 lds
    v_mfma_f32_16x16x32_bf16 v[104:107], a[0:3], v[156:159], 0
    v_fma_f32 v235, v210, v240, v58
    v_fma_f32 v236, v216, v241, v66
    v_fmac_f32_dpp v232, -v237, v193 row_ror:8 row_mask:0xf bank_mask:0xf
    v_mfma_f32_16x16x32_bf16 v[108:111], a[4:7], v[156:159], 0
    v_fmac_f32_dpp v233, -v238, v199 row_ror:8 row_mask:0xf bank_mask:0xf
    v_fmac_f32_dpp v234, -v239, v205 row_ror:8 row_mask:0xf bank_mask:0xf
    v_fmac_f32_dpp v235, -v240, v211 row_ror:8 row_mask:0xf bank_mask:0xf
    s_add_u32 m0, s8, 0
    s_mov_b32 s15, 0
    buffer_load_dwordx4 v184, s[60:63], s15 offen offset:0 lds
    v_mfma_f32_16x16x32_bf16 v[112:115], a[0:3], v[160:163], 0
    v_fmac_f32_dpp v236, -v241, v217 row_ror:8 row_mask:0xf bank_mask:0xf
    v_fma_f32 v237, v192, v232, v35
    v_fma_f32 v238, v198, v233, v43
    v_mfma_f32_16x16x32_bf16 v[116:119], a[4:7], v[160:163], 0
    v_fma_f32 v239, v204, v234, v51
    v_fma_f32 v240, v210, v235, v59
    v_fma_f32 v241, v216, v236, v67
    buffer_load_dwordx4 v185, s[60:63], s15 offen offset:1024 lds
    s_waitcnt lgkmcnt(4)
    v_mfma_f32_16x16x32_bf16 v[80:83], a[8:11], v[164:167], v[80:83]
    ds_read_b128 v[144:147], v6 offset:30720
    v_fmac_f32_dpp v237, -v232, v193 row_ror:8 row_mask:0xf bank_mask:0xf
    v_fmac_f32_dpp v238, -v233, v199 row_ror:8 row_mask:0xf bank_mask:0xf
    v_mfma_f32_16x16x32_bf16 v[84:87], a[12:15], v[164:167], v[84:87]
    ds_read_b128 v[148:151], v6 offset:31104
    s_waitcnt lgkmcnt(4)
    v_fmac_f32_dpp v239, -v234, v205 row_ror:8 row_mask:0xf bank_mask:0xf
    v_fmac_f32_dpp v240, -v235, v211 row_ror:8 row_mask:0xf bank_mask:0xf
    v_mfma_f32_16x16x32_bf16 v[88:91], a[8:11], v[168:171], v[88:91]
    ds_read_b128 v[152:155], v7 offset:30720
    v_fmac_f32_dpp v241, -v236, v217 row_ror:8 row_mask:0xf bank_mask:0xf
    v_fma_f32 v232, v192, v237, v36
    s_add_u32 m0, s8, 2048
    s_mov_b32 s15, 20480
    buffer_load_dwordx4 v184, s[60:63], s15 offen offset:0 lds
    v_mfma_f32_16x16x32_bf16 v[92:95], a[12:15], v[168:171], v[92:95]
    ds_read_b128 v[156:159], v6 offset:31360
    v_fma_f32 v233, v198, v238, v44
    v_fma_f32 v234, v204, v239, v52
    v_mfma_f32_16x16x32_bf16 v[96:99], a[8:11], v[172:175], v[96:99]
    ds_read_b128 v[160:163], v6 offset:31744
    v_fma_f32 v235, v210, v240, v60
    v_fma_f32 v236, v216, v241, v68
    buffer_load_dwordx4 v185, s[60:63], s15 offen offset:1024 lds
    v_mfma_f32_16x16x32_bf16 v[100:103], a[12:15], v[172:175], v[100:103]
    s_waitcnt lgkmcnt(5)
    v_fmac_f32_dpp v232, -v237, v193 row_ror:8 row_mask:0xf bank_mask:0xf
    v_fmac_f32_dpp v233, -v238, v199 row_ror:8 row_mask:0xf bank_mask:0xf
    v_fmac_f32_dpp v234, -v239, v205 row_ror:8 row_mask:0xf bank_mask:0xf
    v_mfma_f32_16x16x32_bf16 v[104:107], a[8:11], v[176:179], v[104:107]
    v_fmac_f32_dpp v235, -v240, v211 row_ror:8 row_mask:0xf bank_mask:0xf
    v_fmac_f32_dpp v236, -v241, v217 row_ror:8 row_mask:0xf bank_mask:0xf
    v_fma_f32 v237, v192, v232, v37
    v_mfma_f32_16x16x32_bf16 v[108:111], a[12:15], v[176:179], v[108:111]
    v_fma_f32 v238, v198, v233, v45
    v_fma_f32 v239, v204, v234, v53
    v_fma_f32 v240, v210, v235, v61
    s_add_u32 m0, s8, 4096
    s_mov_b32 s15, 40960
    buffer_load_dwordx4 v184, s[60:63], s15 offen offset:0 lds
    v_mfma_f32_16x16x32_bf16 v[112:115], a[8:11], v[180:183], v[112:115]
    v_fma_f32 v241, v216, v236, v69
    v_fmac_f32_dpp v237, -v232, v193 row_ror:8 row_mask:0xf bank_mask:0xf
    v_fmac_f32_dpp v238, -v233, v199 row_ror:8 row_mask:0xf bank_mask:0xf
    v_mfma_f32_16x16x32_bf16 v[116:119], a[12:15], v[180:183], v[116:119]
    v_fmac_f32_dpp v239, -v234, v205 row_ror:8 row_mask:0xf bank_mask:0xf
    v_fmac_f32_dpp v240, -v235, v211 row_ror:8 row_mask:0xf bank_mask:0xf
    v_fmac_f32_dpp v241, -v236, v217 row_ror:8 row_mask:0xf bank_mask:0xf
    buffer_load_dwordx4 v185, s[60:63], s15 offen offset:1024 lds
    s_waitcnt lgkmcnt(4)
    v_mfma_f32_16x16x32_bf16 v[80:83], a[16:19], v[144:147], v[80:83]
    ds_read_b128 v[164:167], v6 offset:35840
    v_fma_f32 v232, v192, v237, v38
    v_fma_f32 v233, v198, v238, v46
    v_mfma_f32_16x16x32_bf16 v[84:87], a[20:23], v[144:147], v[84:87]
    ds_read_b128 v[168:171], v6 offset:36224
    s_waitcnt lgkmcnt(4)
    v_fma_f32 v234, v204, v239, v54
    v_fma_f32 v235, v210, v240, v62
    v_mfma_f32_16x16x32_bf16 v[88:91], a[16:19], v[148:151], v[88:91]
    ds_read_b128 v[172:175], v7 offset:35840
    v_fma_f32 v236, v216, v241, v70
    v_fmac_f32_dpp v232, -v237, v193 row_ror:8 row_mask:0xf bank_mask:0xf
    s_add_u32 m0, s8, 6144
    s_mov_b32 s15, 61440
    buffer_load_dwordx4 v184, s[60:63], s15 offen offset:0 lds
    v_mfma_f32_16x16x32_bf16 v[92:95], a[20:23], v[148:151], v[92:95]
    ds_read_b128 v[176:179], v6 offset:36480
    v_fmac_f32_dpp v233, -v238, v199 row_ror:8 row_mask:0xf bank_mask:0xf
    v_fmac_f32_dpp v234, -v239, v205 row_ror:8 row_mask:0xf bank_mask:0xf
    v_mfma_f32_16x16x32_bf16 v[96:99], a[16:19], v[152:155], v[96:99]
    ds_read_b128 v[180:183], v6 offset:36864
    v_fmac_f32_dpp v235, -v240, v211 row_ror:8 row_mask:0xf bank_mask:0xf
    v_fmac_f32_dpp v236, -v241, v217 row_ror:8 row_mask:0xf bank_mask:0xf
    buffer_load_dwordx4 v185, s[60:63], s15 offen offset:1024 lds
    v_mfma_f32_16x16x32_bf16 v[100:103], a[20:23], v[152:155], v[100:103]
    s_waitcnt lgkmcnt(5)
    v_fma_f32 v237, v192, v232, v39
    v_fma_f32 v238, v198, v233, v47
    v_fma_f32 v239, v204, v234, v55
    v_mfma_f32_16x16x32_bf16 v[104:107], a[16:19], v[156:159], v[104:107]
    v_fma_f32 v240, v210, v235, v63
    v_fma_f32 v241, v216, v236, v71
    v_fmac_f32_dpp v237, -v232, v193 row_ror:8 row_mask:0xf bank_mask:0xf
    v_mfma_f32_16x16x32_bf16 v[108:111], a[20:23], v[156:159], v[108:111]
    v_fmac_f32_dpp v238, -v233, v199 row_ror:8 row_mask:0xf bank_mask:0xf
    v_fmac_f32_dpp v239, -v234, v205 row_ror:8 row_mask:0xf bank_mask:0xf
    v_fmac_f32_dpp v240, -v235, v211 row_ror:8 row_mask:0xf bank_mask:0xf
    s_add_u32 m0, s8, 8192
    s_mov_b32 s15, 81920
    buffer_load_dwordx4 v184, s[60:63], s15 offen offset:0 lds
    v_mfma_f32_16x16x32_bf16 v[112:115], a[16:19], v[160:163], v[112:115]
    v_fmac_f32_dpp v241, -v236, v217 row_ror:8 row_mask:0xf bank_mask:0xf
    ds_write_b32 v190, v237 offset:4
    ds_write_b32 v190, v238 offset:1284
    v_mfma_f32_16x16x32_bf16 v[116:119], a[20:23], v[160:163], v[116:119]
    ds_write_b32 v190, v239 offset:2564
    ds_write_b32 v190, v240 offset:3844
    ds_write_b32 v190, v241 offset:5124
    buffer_load_dwordx4 v185, s[60:63], s15 offen offset:1024 lds
    s_waitcnt lgkmcnt(9)
    s_waitcnt lgkmcnt(5)
    s_waitcnt lgkmcnt(0) vmcnt(20)
    s_barrier
    v_mfma_f32_16x16x32_bf16 v[80:83], a[24:27], v[164:167], v[80:83]
    ds_read_b128 v[144:147], v8 offset:0
    v_mul_f32_dpp v248, v32, v195 row_ror:8 row_mask:0xf bank_mask:0xf
    v_mul_f32_dpp v249, v40, v201 row_ror:8 row_mask:0xf bank_mask:0xf
    s_add_u32 m0, s9, 20480
    s_add_u32 s15, s2, 81920
    s_sub_u32 s31, s15, 102400
    s_min_u32 s15, s15, s31
    s_add_u32 s15, s15, s16
    buffer_load_dwordx4 v20, s[64:67], s15 offen offset:0 sc1 lds
    v_mfma_f32_16x16x32_bf16 v[84:87], a[28:31], v[164:167], v[84:87]
    ds_read_b128 v[148:151], v8 offset:384
    v_mul_f32_dpp v250, v48, v207 row_ror:8 row_mask:0xf bank_mask:0xf
    v_mul_f32_dpp v251, v56, v213 row_ror:8 row_mask:0xf bank_mask:0xf
    s_waitcnt vmcnt(9)
    ds_read_b128 a[160:163], v4 offset:0
    ds_read_b128 a[164:167], v5 offset:0
    v_mfma_f32_16x16x32_bf16 v[88:91], a[24:27], v[168:171], v[88:91]
    ds_read_b128 v[152:155], v9 offset:0
    v_mul_f32_dpp v252, v64, v219 row_ror:8 row_mask:0xf bank_mask:0xf
    v_fma_f32 v32, v32, v194, v248
    buffer_load_dwordx4 v20, s[64:67], s15 offen offset:1024 sc1 lds
    v_mfma_f32_16x16x32_bf16 v[92:95], a[28:31], v[168:171], v[92:95]
    ds_read_b128 v[156:159], v8 offset:640
    v_fma_f32 v40, v40, v200, v249
    v_fma_f32 v48, v48, v206, v250
    v_mfma_f32_16x16x32_bf16 v[96:99], a[24:27], v[172:175], v[96:99]
    ds_read_b128 v[160:163], v8 offset:1024
    v_fma_f32 v56, v56, v212, v251
    v_fma_f32 v64, v64, v218, v252
    v_mfma_f32_16x16x32_bf16 v[100:103], a[28:31], v[172:175], v[100:103]
    ds_read_b128 v[120:123], v186 offset:16
    v_mul_f32_dpp v248, v33, v195 row_ror:8 row_mask:0xf bank_mask:0xf
    v_mul_f32_dpp v249, v41, v201 row_ror:8 row_mask:0xf bank_mask:0xf
    buffer_load_dwordx4 v20, s[64:67], s15 offen offset:2048 sc1 lds
    v_mfma_f32_16x16x32_bf16 v[104:107], a[24:27], v[176:179], v[104:107]
    ds_read_b128 v[124:127], v186 offset:32
    v_mul_f32_dpp v250, v49, v207 row_ror:8 row_mask:0xf bank_mask:0xf
    v_mul_f32_dpp v251, v57, v213 row_ror:8 row_mask:0xf bank_mask:0xf
    s_waitcnt vmcnt(9)
    ds_read_b128 a[168:171], v4 offset:2048
    ds_read_b128 a[172:175], v5 offset:2048
    v_mfma_f32_16x16x32_bf16 v[108:111], a[28:31], v[176:179], v[108:111]
    ds_read_b128 v[128:131], v186 offset:48
    v_mul_f32_dpp v252, v65, v219 row_ror:8 row_mask:0xf bank_mask:0xf
    v_fma_f32 v33, v33, v194, v248
    buffer_load_dwordx4 v20, s[64:67], s15 offen offset:3072 sc1 lds
    v_mfma_f32_16x16x32_bf16 v[112:115], a[24:27], v[180:183], v[112:115]
    ds_read_b128 v[132:135], v186 offset:64
    v_fma_f32 v41, v41, v200, v249
    v_fma_f32 v49, v49, v206, v250
    v_mfma_f32_16x16x32_bf16 v[116:119], a[28:31], v[180:183], v[116:119]
    v_fma_f32 v57, v57, v212, v251
    v_fma_f32 v65, v65, v218, v252
    s_waitcnt lgkmcnt(12)
    v_mfma_f32_16x16x32_bf16 v[80:83], a[32:35], v[144:147], v[80:83]
    ds_read_b128 v[164:167], v8 offset:5120
    s_add_u32 m0, s9, 24576
    s_add_u32 s15, s15, 4096
    buffer_load_dwordx4 v20, s[64:67], s15 offen sc1 lds
    v_mfma_f32_16x16x32_bf16 v[84:87], a[36:39], v[144:147], v[84:87]
    ds_read_b128 v[168:171], v8 offset:5504
    s_waitcnt lgkmcnt(10) vmcnt(9)
    ds_read_b128 a[176:179], v4 offset:4096
    ds_read_b128 a[180:183], v5 offset:4096
    v_mfma_f32_16x16x32_bf16 v[88:91], a[32:35], v[148:151], v[88:91]
    ds_read_b128 v[172:175], v9 offset:5120
    s_add_u32 m0, s8, 10240
    s_mov_b32 s15, 128
    buffer_load_dwordx4 v184, s[60:63], s15 offen offset:0 lds
    v_mfma_f32_16x16x32_bf16 v[92:95], a[36:39], v[148:151], v[92:95]
    ds_read_b128 v[176:179], v8 offset:5760
    s_waitcnt lgkmcnt(6)
    v_mfma_f32_16x16x32_bf16 v[96:99], a[32:35], v[152:155], v[96:99]
    ds_read_b128 v[180:183], v8 offset:6144
    v_fmac_f32 v121, v22, v120
    v_fmac_f32_dpp v121, -v120, v23 row_ror:8 row_mask:0xf bank_mask:0xf
    v_mfma_f32_16x16x32_bf16 v[100:103], a[36:39], v[152:155], v[100:103]
    v_fmac_f32 v122, v22, v121
    v_fmac_f32_dpp v122, -v121, v23 row_ror:8 row_mask:0xf bank_mask:0xf
    buffer_load_dwordx4 v185, s[60:63], s15 offen offset:1024 lds
    v_mfma_f32_16x16x32_bf16 v[104:107], a[32:35], v[156:159], v[104:107]
    v_fmac_f32 v123, v22, v122
    v_fmac_f32_dpp v123, -v122, v23 row_ror:8 row_mask:0xf bank_mask:0xf
    s_waitcnt vmcnt(9)
    ds_read_b128 a[184:187], v4 offset:6144
    ds_read_b128 a[188:191], v5 offset:6144
    v_mfma_f32_16x16x32_bf16 v[108:111], a[36:39], v[156:159], v[108:111]
    v_fmac_f32 v124, v22, v123
    v_fmac_f32_dpp v124, -v123, v23 row_ror:8 row_mask:0xf bank_mask:0xf
    s_add_u32 m0, s8, 0
    s_mov_b32 s15, 20608
    buffer_load_dwordx4 v184, s[60:63], s15 offen offset:0 lds
    v_mfma_f32_16x16x32_bf16 v[112:115], a[32:35], v[160:163], v[112:115]
    v_fmac_f32 v125, v22, v124
    v_fmac_f32_dpp v125, -v124, v23 row_ror:8 row_mask:0xf bank_mask:0xf
    v_mfma_f32_16x16x32_bf16 v[116:119], a[36:39], v[160:163], v[116:119]
    v_fmac_f32 v126, v22, v125
    v_fmac_f32_dpp v126, -v125, v23 row_ror:8 row_mask:0xf bank_mask:0xf
    s_waitcnt lgkmcnt(8)
    v_mfma_f32_16x16x32_bf16 v[80:83], a[40:43], v[164:167], v[80:83]
    ds_read_b128 v[144:147], v8 offset:10240
    v_fmac_f32 v127, v22, v126
    v_fmac_f32_dpp v127, -v126, v23 row_ror:8 row_mask:0xf bank_mask:0xf
    buffer_load_dwordx4 v185, s[60:63], s15 offen offset:1024 lds
    v_mfma_f32_16x16x32_bf16 v[84:87], a[44:47], v[164:167], v[84:87]
    ds_read_b128 v[148:151], v8 offset:10624
    s_waitcnt lgkmcnt(6)
    v_fmac_f32 v128, v22, v127
    v_fmac_f32_dpp v128, -v127, v23 row_ror:8 row_mask:0xf bank_mask:0xf
    v_mfma_f32_16x16x32_bf16 v[88:91], a[40:43], v[168:171], v[88:91]
    ds_read_b128 v[152:155], v9 offset:10240
    v_fmac_f32 v129, v22, v128
    v_fmac_f32_dpp v129, -v128, v23 row_ror:8 row_mask:0xf bank_mask:0xf
    s_waitcnt vmcnt(9)
    ds_read_b128 a[192:195], v4 offset:8192
    ds_read_b128 a[196:199], v5 offset:8192
    s_add_u32 m0, s8, 2048
    s_mov_b32 s15, 41088
    buffer_load_dwordx4 v184, s[60:63], s15 offen offset:0 lds
    v_mfma_f32_16x16x32_bf16 v[92:95], a[44:47], v[168:171], v[92:95]
    ds_read_b128 v[156:159], v8 offset:10880
    v_fmac_f32 v130, v22, v129
    v_fmac_f32_dpp v130, -v129, v23 row_ror:8 row_mask:0xf bank_mask:0xf
    v_mfma_f32_16x16x32_bf16 v[96:99], a[40:43], v[172:175], v[96:99]
    ds_read_b128 v[160:163], v8 offset:11264
    v_fmac_f32 v131, v22, v130
    v_fmac_f32_dpp v131, -v130, v23 row_ror:8 row_mask:0xf bank_mask:0xf
    buffer_load_dwordx4 v185, s[60:63], s15 offen offset:1024 lds
    v_mfma_f32_16x16x32_bf16 v[100:103], a[44:47], v[172:175], v[100:103]
    s_waitcnt lgkmcnt(9)
    v_fmac_f32 v132, v22, v131
    v_fmac_f32_dpp v132, -v131, v23 row_ror:8 row_mask:0xf bank_mask:0xf
    v_mfma_f32_16x16x32_bf16 v[104:107], a[40:43], v[176:179], v[104:107]
    v_fmac_f32 v133, v22, v132
    v_fmac_f32_dpp v133, -v132, v23 row_ror:8 row_mask:0xf bank_mask:0xf
    v_mfma_f32_16x16x32_bf16 v[108:111], a[44:47], v[176:179], v[108:111]
    v_fmac_f32 v134, v22, v133
    v_fmac_f32_dpp v134, -v133, v23 row_ror:8 row_mask:0xf bank_mask:0xf
    s_add_u32 m0, s8, 4096
    s_mov_b32 s15, 61568
    buffer_load_dwordx4 v184, s[60:63], s15 offen offset:0 lds
    v_mfma_f32_16x16x32_bf16 v[112:115], a[40:43], v[180:183], v[112:115]
    v_fmac_f32 v135, v22, v134
    v_fmac_f32_dpp v135, -v134, v23 row_ror:8 row_mask:0xf bank_mask:0xf
    v_min_u32 v135, -2, v135
    v_mfma_f32_16x16x32_bf16 v[116:119], a[44:47], v[180:183], v[116:119]
    buffer_store_dword v135, v21, s[76:79], s34 offen sc1
    s_waitcnt lgkmcnt(6)
    v_mfma_f32_16x16x32_bf16 v[80:83], a[48:51], v[144:147], v[80:83]
    ds_read_b128 v[164:167], v8 offset:15360
    v_mul_f32_dpp v248, v34, v195 row_ror:8 row_mask:0xf bank_mask:0xf
    v_mul_f32_dpp v249, v42, v201 row_ror:8 row_mask:0xf bank_mask:0xf
    v_mfma_f32_16x16x32_bf16 v[84:87], a[52:55], v[144:147], v[84:87]
    ds_read_b128 v[168:171], v8 offset:15744
    s_waitcnt lgkmcnt(6)
    v_mul_f32_dpp v250, v50, v207 row_ror:8 row_mask:0xf bank_mask:0xf
    v_mul_f32_dpp v251, v58, v213 row_ror:8 row_mask:0xf bank_mask:0xf
    v_mfma_f32_16x16x32_bf16 v[88:91], a[48:51], v[148:151], v[88:91]
    ds_read_b128 v[172:175], v9 offset:15360
    v_mul_f32_dpp v252, v66, v219 row_ror:8 row_mask:0xf bank_mask:0xf
    v_fma_f32 v34, v34, v194, v248
    buffer_load_dwordx4 v185, s[60:63], s15 offen offset:1024 lds
    v_mfma_f32_16x16x32_bf16 v[92:95], a[52:55], v[148:151], v[92:95]
    ds_read_b128 v[176:179], v8 offset:16000
    v_fma_f32 v42, v42, v200, v249
    v_fma_f32 v50, v50, v206, v250
    v_mfma_f32_16x16x32_bf16 v[96:99], a[48:51], v[152:155], v[96:99]
    ds_read_b128 v[180:183], v8 offset:16384
    v_fma_f32 v58, v58, v212, v251
    v_fma_f32 v66, v66, v218, v252
    v_mfma_f32_16x16x32_bf16 v[100:103], a[52:55], v[152:155], v[100:103]
    s_waitcnt lgkmcnt(5)
    v_mul_f32_dpp v248, v35, v195 row_ror:8 row_mask:0xf bank_mask:0xf
    v_mul_f32_dpp v249, v43, v201 row_ror:8 row_mask:0xf bank_mask:0xf
    v_mul_f32_dpp v250, v51, v207 row_ror:8 row_mask:0xf bank_mask:0xf
    s_add_u32 m0, s8, 6144
    s_mov_b32 s15, 82048
    buffer_load_dwordx4 v184, s[60:63], s15 offen offset:0 lds
    v_mfma_f32_16x16x32_bf16 v[104:107], a[48:51], v[156:159], v[104:107]
    v_mul_f32_dpp v251, v59, v213 row_ror:8 row_mask:0xf bank_mask:0xf
    v_mul_f32_dpp v252, v67, v219 row_ror:8 row_mask:0xf bank_mask:0xf
    v_fma_f32 v35, v35, v194, v248
    v_mfma_f32_16x16x32_bf16 v[108:111], a[52:55], v[156:159], v[108:111]
    v_fma_f32 v43, v43, v200, v249
    v_fma_f32 v51, v51, v206, v250
    v_fma_f32 v59, v59, v212, v251
    buffer_load_dwordx4 v185, s[60:63], s15 offen offset:1024 lds
    v_mfma_f32_16x16x32_bf16 v[112:115], a[48:51], v[160:163], v[112:115]
    v_fma_f32 v67, v67, v218, v252
    v_mul_f32_dpp v248, v36, v195 row_ror:8 row_mask:0xf bank_mask:0xf
    v_mul_f32_dpp v249, v44, v201 row_ror:8 row_mask:0xf bank_mask:0xf
    v_mfma_f32_16x16x32_bf16 v[116:119], a[52:55], v[160:163], v[116:119]
    v_mul_f32_dpp v250, v52, v207 row_ror:8 row_mask:0xf bank_mask:0xf
    v_mul_f32_dpp v251, v60, v213 row_ror:8 row_mask:0xf bank_mask:0xf
    v_mul_f32_dpp v252, v68, v219 row_ror:8 row_mask:0xf bank_mask:0xf
    s_waitcnt lgkmcnt(4)
    s_waitcnt lgkmcnt(0)
    s_barrier
    v_mfma_f32_16x16x32_bf16 v[80:83], a[56:59], v[164:167], v[80:83]
    ds_read_b128 v[144:147], v8 offset:20480
    v_fma_f32 v36, v36, v194, v248
    v_fma_f32 v44, v44, v200, v249
    s_waitcnt vmcnt(9)
    ds_read_b128 a[200:203], v4 offset:10240
    ds_read_b128 a[204:207], v5 offset:10240
    s_add_u32 m0, s9, 40960
    s_add_u32 s15, s38, 0
    s_sub_u32 s31, s15, 51200
    s_min_u32 s15, s15, s31
    s_add_u32 s15, s15, s36
    buffer_load_dwordx4 v20, s[64:67], s15 offen offset:0 sc1 lds
    v_mfma_f32_16x16x32_bf16 v[84:87], a[60:63], v[164:167], v[84:87]
    ds_read_b128 v[148:151], v8 offset:20864
    v_fma_f32 v52, v52, v206, v250
    v_fma_f32 v60, v60, v212, v251
    buffer_load_dwordx4 v20, s[64:67], s15 offen offset:1024 sc1 lds
    v_mfma_f32_16x16x32_bf16 v[88:91], a[56:59], v[168:171], v[88:91]
    ds_read_b128 v[152:155], v9 offset:20480
    v_fma_f32 v68, v68, v218, v252
    v_mul_f32_dpp v248, v37, v195 row_ror:8 row_mask:0xf bank_mask:0xf
    v_mfma_f32_16x16x32_bf16 v[92:95], a[60:63], v[168:171], v[92:95]
    ds_read_b128 v[156:159], v8 offset:21120
    v_mul_f32_dpp v249, v45, v201 row_ror:8 row_mask:0xf bank_mask:0xf
    v_mul_f32_dpp v250, v53, v207 row_ror:8 row_mask:0xf bank_mask:0xf
    buffer_load_dwordx4 v20, s[64:67], s15 offen offset:2048 sc1 lds
    v_mfma_f32_16x16x32_bf16 v[96:99], a[56:59], v[172:175], v[96:99]
    ds_read_b128 v[160:163], v8 offset:21504
    v_mul_f32_dpp v251, v61, v213 row_ror:8 row_mask:0xf bank_mask:0xf
    v_mul_f32_dpp v252, v69, v219 row_ror:8 row_mask:0xf bank_mask:0xf
    s_waitcnt vmcnt(10)
    ds_read_b128 a[208:211], v4 offset:0
    ds_read_b128 a[212:215], v5 offset:0
    v_mfma_f32_16x16x32_bf16 v[100:103], a[60:63], v[172:175], v[100:103]
    s_cmp_ge_u32 s3, 2
    s_cbranch_scc0 L_skip_9
    ds_write_b32 v186, v141 offset:12
    ds_write_b128 v186, v[120:123] offset:16
    ds_write_b128 v186, v[124:127] offset:32
    ds_write_b128 v186, v[128:131] offset:48
    ds_write_b128 v186, v[132:135] offset:64
L_skip_9:
    buffer_load_dwordx4 v20, s[64:67], s15 offen offset:3072 sc1 lds
    v_mfma_f32_16x16x32_bf16 v[104:107], a[56:59], v[176:179], v[104:107]
    v_fma_f32 v37, v37, v194, v248
    v_fma_f32 v45, v45, v200, v249
    v_fma_f32 v53, v53, v206, v250
    s_waitcnt vmcnt(9)
    ds_read_b128 a[216:219], v4 offset:2048
    ds_read_b128 a[220:223], v5 offset:2048
    s_add_u32 m0, s9, 45056
    s_add_u32 s15, s15, 4096
    buffer_load_dwordx4 v20, s[64:67], s15 offen sc1 lds
    v_mfma_f32_16x16x32_bf16 v[108:111], a[60:63], v[176:179], v[108:111]
    v_fma_f32 v61, v61, v212, v251
    v_fma_f32 v69, v69, v218, v252
    v_mul_f32_dpp v248, v38, v195 row_ror:8 row_mask:0xf bank_mask:0xf
    v_mfma_f32_16x16x32_bf16 v[112:115], a[56:59], v[180:183], v[112:115]
    v_mul_f32_dpp v249, v46, v201 row_ror:8 row_mask:0xf bank_mask:0xf
    v_mul_f32_dpp v250, v54, v207 row_ror:8 row_mask:0xf bank_mask:0xf
    v_mul_f32_dpp v251, v62, v213 row_ror:8 row_mask:0xf bank_mask:0xf
    s_waitcnt vmcnt(7)
    ds_read_b128 a[224:227], v4 offset:4096
    ds_read_b128 a[228:231], v5 offset:4096
    s_add_u32 m0, s8, 8192
    s_mov_b32 s15, 256
    buffer_load_dwordx4 v184, s[60:63], s15 offen offset:0 lds
    v_mfma_f32_16x16x32_bf16 v[116:119], a[60:63], v[180:183], v[116:119]
    v_mul_f32_dpp v252, v70, v219 row_ror:8 row_mask:0xf bank_mask:0xf
    v_fma_f32 v38, v38, v194, v248
    v_fma_f32 v46, v46, v200, v249
    buffer_load_dwordx4 v185, s[60:63], s15 offen offset:1024 lds
    s_waitcnt lgkmcnt(12)
    v_mfma_f32_16x16x32_bf16 v[80:83], a[64:67], v[144:147], v[80:83]
    ds_read_b128 v[164:167], v8 offset:25600
    v_fma_f32 v54, v54, v206, v250
    v_fma_f32 v62, v62, v212, v251
    v_mfma_f32_16x16x32_bf16 v[84:87], a[68:71], v[144:147], v[84:87]
    ds_read_b128 v[168:171], v8 offset:25984
    s_waitcnt lgkmcnt(10)
    v_fma_f32 v70, v70, v218, v252
    v_mul_f32_dpp v248, v39, v195 row_ror:8 row_mask:0xf bank_mask:0xf
    v_mfma_f32_16x16x32_bf16 v[88:91], a[64:67], v[148:151], v[88:91]
    ds_read_b128 v[172:175], v9 offset:25600
    v_mul_f32_dpp v249, v47, v201 row_ror:8 row_mask:0xf bank_mask:0xf
    v_mul_f32_dpp v250, v55, v207 row_ror:8 row_mask:0xf bank_mask:0xf
    s_waitcnt vmcnt(7)
    ds_read_b128 a[232:235], v4 offset:6144
    ds_read_b128 a[236:239], v5 offset:6144
    s_add_u32 m0, s8, 10240
    s_mov_b32 s15, 20736
    buffer_load_dwordx4 v184, s[60:63], s15 offen offset:0 lds
    v_mfma_f32_16x16x32_bf16 v[92:95], a[68:71], v[148:151], v[92:95]
    ds_read_b128 v[176:179], v8 offset:26240
    v_mul_f32_dpp v251, v63, v213 row_ror:8 row_mask:0xf bank_mask:0xf
    v_mul_f32_dpp v252, v71, v219 row_ror:8 row_mask:0xf bank_mask:0xf
    buffer_load_dwordx4 v185, s[60:63], s15 offen offset:1024 lds
    v_mfma_f32_16x16x32_bf16 v[96:99], a[64:67], v[152:155], v[96:99]
    ds_read_b128 v[180:183], v8 offset:26624
    v_fma_f32 v39, v39, v194, v248
    v_fma_f32 v47, v47, v200, v249
    v_mfma_f32_16x16x32_bf16 v[100:103], a[68:71], v[152:155], v[100:103]
    s_waitcnt lgkmcnt(13)
    v_fma_f32 v55, v55, v206, v250
    v_fma_f32 v63, v63, v212, v251
    v_fma_f32 v71, v71, v218, v252
    v_mfma_f32_16x16x32_bf16 v[104:107], a[64:67], v[156:159], v[104:107]
    s_waitcnt lgkmcnt(11)
    s_add_u32 m0, s8, 0
    s_mov_b32 s15, 41216
    buffer_load_dwordx4 v184, s[60:63], s15 offen offset:0 lds
    v_mfma_f32_16x16x32_bf16 v[108:111], a[68:71], v[156:159], v[108:111]
    v_mfma_f32_16x16x32_bf16 v[112:115], a[64:67], v[160:163], v[112:115]
    v_mfma_f32_16x16x32_bf16 v[116:119], a[68:71], v[160:163], v[116:119]
    buffer_load_dwordx4 v185, s[60:63], s15 offen offset:1024 lds
    s_waitcnt lgkmcnt(6)
    v_mfma_f32_16x16x32_bf16 v[80:83], a[72:75], v[164:167], v[80:83]
    ds_read_b128 v[144:147], v8 offset:30720
    s_cmp_lt_u32 s3, 2
    s_cbranch_scc0 L_skip_10
    buffer_load_dword v246, v21, s[76:79], s24 offen offset:3072 sc1
    buffer_load_dword v245, v21, s[76:79], s24 offen offset:2560 sc1
    buffer_load_dword v244, v21, s[76:79], s24 offen offset:2048 sc1
    buffer_load_dword v243, v21, s[76:79], s24 offen offset:1536 sc1
    buffer_load_dword v242, v21, s[76:79], s24 offen offset:1024 sc1
    buffer_load_dword v241, v21, s[76:79], s24 offen offset:512 sc1
    buffer_load_dword v240, v21, s[76:79], s24 offen offset:0 sc1
    buffer_load_dword v239, v21, s[76:79], s17 offen offset:3584 sc1
L_skip_10:
    v_mfma_f32_16x16x32_bf16 v[84:87], a[76:79], v[164:167], v[84:87]
    ds_read_b128 v[148:151], v8 offset:31104
    s_waitcnt lgkmcnt(6)
    s_add_u32 m0, s8, 2048
    s_mov_b32 s15, 61696
    buffer_load_dwordx4 v184, s[60:63], s15 offen offset:0 lds
    v_mfma_f32_16x16x32_bf16 v[88:91], a[72:75], v[168:171], v[88:91]
    ds_read_b128 v[152:155], v9 offset:30720
    v_mfma_f32_16x16x32_bf16 v[92:95], a[76:79], v[168:171], v[92:95]
    ds_read_b128 v[156:159], v8 offset:31360
    v_mfma_f32_16x16x32_bf16 v[96:99], a[72:75], v[172:175], v[96:99]
    ds_read_b128 v[160:163], v8 offset:31744
    buffer_load_dwordx4 v185, s[60:63], s15 offen offset:1024 lds
    v_mfma_f32_16x16x32_bf16 v[100:103], a[76:79], v[172:175], v[100:103]
    s_waitcnt lgkmcnt(5)
    s_cmp_lt_u32 s3, 2
    s_cbranch_scc0 L_skip_11
    buffer_load_dword v238, v21, s[76:79], s17 offen offset:3072 sc1
    buffer_load_dword v237, v21, s[76:79], s17 offen offset:2560 sc1
    buffer_load_dword v236, v21, s[76:79], s17 offen offset:2048 sc1
    buffer_load_dword v235, v21, s[76:79], s17 offen offset:1536 sc1
    buffer_load_dword v234, v21, s[76:79], s17 offen offset:1024 sc1
    buffer_load_dword v233, v21, s[76:79], s17 offen offset:512 sc1
    buffer_load_dword v232, v21, s[76:79], s17 offen offset:0 sc1
L_skip_11:
    v_mfma_f32_16x16x32_bf16 v[104:107], a[72:75], v[176:179], v[104:107]
    s_add_u32 m0, s8, 4096
    s_mov_b32 s15, 82176
    buffer_load_dwordx4 v184, s[60:63], s15 offen offset:0 lds
    v_mfma_f32_16x16x32_bf16 v[108:111], a[76:79], v[176:179], v[108:111]
    v_mfma_f32_16x16x32_bf16 v[112:115], a[72:75], v[180:183], v[112:115]
    v_mfma_f32_16x16x32_bf16 v[116:119], a[76:79], v[180:183], v[116:119]
    buffer_load_dwordx4 v185, s[60:63], s15 offen offset:1024 lds
    s_waitcnt lgkmcnt(4)
    v_mfma_f32_16x16x32_bf16 v[80:83], a[80:83], v[144:147], v[80:83]
    ds_read_b128 v[164:167], v8 offset:35840
    s_waitcnt vmcnt(8)
    ds_read_b128 a[240:243], v4 offset:8192
    ds_read_b128 a[244:247], v5 offset:8192
    v_mfma_f32_16x16x32_bf16 v[84:87], a[84:87], v[144:147], v[84:87]
    ds_read_b128 v[168:171], v8 offset:36224
    s_waitcnt lgkmcnt(6)
    v_mfma_f32_16x16x32_bf16 v[88:91], a[80:83], v[148:151], v[88:91]
    ds_read_b128 v[172:175], v9 offset:35840
    s_add_u32 m0, s8, 6144
    s_mov_b32 s15, 384
    buffer_load_dwordx4 v184, s[60:63], s15 offen offset:0 lds
    v_mfma_f32_16x16x32_bf16 v[92:95], a[84:87], v[148:151], v[92:95]
    ds_read_b128 v[176:179], v8 offset:36480
    v_mfma_f32_16x16x32_bf16 v[96:99], a[80:83], v[152:155], v[96:99]
    ds_read_b128 v[180:183], v8 offset:36864
    v_mfma_f32_16x16x32_bf16 v[100:103], a[84:87], v[152:155], v[100:103]
    s_waitcnt lgkmcnt(7)
    buffer_load_dwordx4 v185, s[60:63], s15 offen offset:1024 lds
    v_mfma_f32_16x16x32_bf16 v[104:107], a[80:83], v[156:159], v[104:107]
    s_waitcnt vmcnt(8)
    ds_read_b128 a[248:251], v4 offset:10240
    ds_read_b128 a[252:255], v5 offset:10240
    v_mfma_f32_16x16x32_bf16 v[108:111], a[84:87], v[156:159], v[108:111]
    v_mfma_f32_16x16x32_bf16 v[112:115], a[80:83], v[160:163], v[112:115]
    s_waitcnt lgkmcnt(6)
    s_add_u32 m0, s8, 8192
    s_mov_b32 s15, 20864
    buffer_load_dwordx4 v184, s[60:63], s15 offen offset:0 lds
    v_mfma_f32_16x16x32_bf16 v[116:119], a[84:87], v[160:163], v[116:119]
    s_waitcnt lgkmcnt(2)
    s_barrier
    v_mfma_f32_16x16x32_bf16 v[80:83], a[88:91], v[164:167], v[80:83]
    ds_read_b128 v[144:147], v6 offset:0
    buffer_load_dwordx4 v185, s[60:63], s15 offen offset:1024 lds
    v_mfma_f32_16x16x32_bf16 v[84:87], a[92:95], v[164:167], v[84:87]
    ds_read_b128 v[148:151], v6 offset:384
    v_mfma_f32_16x16x32_bf16 v[88:91], a[88:91], v[168:171], v[88:91]
    ds_read_b128 v[152:155], v7 offset:0
    v_mfma_f32_16x16x32_bf16 v[92:95], a[92:95], v[168:171], v[92:95]
    ds_read_b128 v[156:159], v6 offset:640
    s_add_u32 m0, s9, 61440
    s_add_u32 s15, s38, 20480
    s_sub_u32 s31, s15, 51200
    s_min_u32 s15, s15, s31
    s_add_u32 s15, s15, s36
    buffer_load_dwordx4 v20, s[64:67], s15 offen offset:0 sc1 lds
    v_mfma_f32_16x16x32_bf16 v[96:99], a[88:91], v[172:175], v[96:99]
    ds_read_b128 v[160:163], v6 offset:1024
    v_mfma_f32_16x16x32_bf16 v[100:103], a[92:95], v[172:175], v[100:103]
    ds_read_b32 v136, v190 offset:0
    v_mfma_f32_16x16x32_bf16 v[104:107], a[88:91], v[176:179], v[104:107]
    ds_read_b32 v137, v190 offset:1280
    buffer_load_dwordx4 v20, s[64:67], s15 offen offset:1024 sc1 lds
    v_mfma_f32_16x16x32_bf16 v[108:111], a[92:95], v[176:179], v[108:111]
    ds_read_b32 v138, v190 offset:2560
    v_mfma_f32_16x16x32_bf16 v[112:115], a[88:91], v[180:183], v[112:115]
    ds_read_b32 v139, v190 offset:3840
    v_mfma_f32_16x16x32_bf16 v[116:119], a[92:95], v[180:183], v[116:119]
    ds_read_b32 v140, v190 offset:5120
    buffer_load_dwordx4 v20, s[64:67], s15 offen offset:2048 sc1 lds
    s_waitcnt lgkmcnt(9)
    v_mfma_f32_16x16x32_bf16 v[80:83], a[96:99], v[144:147], v[80:83]
    ds_read_b128 v[164:167], v6 offset:5120
    s_waitcnt vmcnt(9)
    v_max3_u32 v247, v232, v233, v234
    v_mfma_f32_16x16x32_bf16 v[84:87], a[100:103], v[144:147], v[84:87]
    ds_read_b128 v[168:171], v6 offset:5504
    s_waitcnt lgkmcnt(9)
    v_max3_u32 v247, v247, v235, v236
    v_mfma_f32_16x16x32_bf16 v[88:91], a[96:99], v[148:151], v[88:91]
    ds_read_b128 v[172:175], v7 offset:5120
    v_max3_u32 v247, v247, v237, v238
    buffer_load_dwordx4 v20, s[64:67], s15 offen offset:3072 sc1 lds
    v_mfma_f32_16x16x32_bf16 v[92:95], a[100:103], v[148:151], v[92:95]
    ds_read_b128 v[176:179], v6 offset:5760
    s_waitcnt lgkmcnt(4)
    v_max3_u32 v247, v247, v239, v240
    v_mfma_f32_16x16x32_bf16 v[96:99], a[96:99], v[152:155], v[96:99]
    ds_read_b128 v[180:183], v6 offset:6144
    v_mul_f32_dpp v248, v136, v195 row_ror:8 row_mask:0xf bank_mask:0xf
    v_mfma_f32_16x16x32_bf16 v[100:103], a[100:103], v[152:155], v[100:103]
    v_mul_f32_dpp v249, v137, v201 row_ror:8 row_mask:0xf bank_mask:0xf
    v_mul_f32_dpp v250, v138, v207 row_ror:8 row_mask:0xf bank_mask:0xf
    s_add_u32 m0, s9, 65536
    s_add_u32 s15, s15, 4096
    buffer_load_dwordx4 v20, s[64:67], s15 offen sc1 lds
    v_mfma_f32_16x16x32_bf16 v[104:107], a[96:99], v[156:159], v[104:107]
    v_mul_f32_dpp v251, v139, v213 row_ror:8 row_mask:0xf bank_mask:0xf
    v_mul_f32_dpp v252, v140, v219 row_ror:8 row_mask:0xf bank_mask:0xf
    v_mfma_f32_16x16x32_bf16 v[108:111], a[100:103], v[156:159], v[108:111]
    v_fma_f32 v136, v136, v194, v248
    v_fma_f32 v137, v137, v200, v249
    v_mfma_f32_16x16x32_bf16 v[112:115], a[96:99], v[160:163], v[112:115]
    v_fma_f32 v138, v138, v206, v250
    v_fma_f32 v139, v139, v212, v251
    s_add_u32 m0, s8, 10240
    s_mov_b32 s15, 41344
    buffer_load_dwordx4 v184, s[60:63], s15 offen offset:0 lds
    v_mfma_f32_16x16x32_bf16 v[116:119], a[100:103], v[160:163], v[116:119]
    v_fma_f32 v140, v140, v218, v252
    v_max3_u32 v247, v247, v241, v242
    s_waitcnt lgkmcnt(4)
    v_mfma_f32_16x16x32_bf16 v[80:83], a[104:107], v[164:167], v[80:83]
    ds_read_b128 v[144:147], v6 offset:10240
    v_max3_u32 v247, v247, v243, v244
    buffer_load_dwordx4 v185, s[60:63], s15 offen offset:1024 lds
    v_mfma_f32_16x16x32_bf16 v[84:87], a[108:111], v[164:167], v[84:87]
    ds_read_b128 v[148:151], v6 offset:10624
    s_waitcnt lgkmcnt(4)
    v_max3_u32 v247, v247, v245, v246
    v_mfma_f32_16x16x32_bf16 v[88:91], a[104:107], v[168:171], v[88:91]
    ds_read_b128 v[152:155], v7 offset:10240
    v_cmp_eq_u32 vcc, -1, v247
    s_nop 0
    s_and_b64 vcc, vcc, s[46:47]
    s_cbranch_scc1 L_slow_12
L_back_13:
    v_mfma_f32_16x16x32_bf16 v[92:95], a[108:111], v[168:171], v[92:95]
    ds_read_b128 v[156:159], v6 offset:10880
    v_fmac_f32 v245, v24, v246
    v_fmac_f32_dpp v245, -v246, v25 row_ror:8 row_mask:0xf bank_mask:0xf
    v_mfma_f32_16x16x32_bf16 v[96:99], a[104:107], v[172:175], v[96:99]
    ds_read_b128 v[160:163], v6 offset:11264
    v_fmac_f32 v244, v24, v245
    v_fmac_f32_dpp v244, -v245, v25 row_ror:8 row_mask:0xf bank_mask:0xf
    v_mfma_f32_16x16x32_bf16 v[100:103], a[108:111], v[172:175], v[100:103]
    s_waitcnt lgkmcnt(5)
    v_fmac_f32 v243, v24, v244
    v_fmac_f32_dpp v243, -v244, v25 row_ror:8 row_mask:0xf bank_mask:0xf
    v_mfma_f32_16x16x32_bf16 v[104:107], a[104:107], v[176:179], v[104:107]
    v_fmac_f32 v242, v24, v243
    v_fmac_f32_dpp v242, -v243, v25 row_ror:8 row_mask:0xf bank_mask:0xf
    v_mfma_f32_16x16x32_bf16 v[108:111], a[108:111], v[176:179], v[108:111]
    v_fmac_f32 v241, v24, v242
    v_fmac_f32_dpp v241, -v242, v25 row_ror:8 row_mask:0xf bank_mask:0xf
    v_mfma_f32_16x16x32_bf16 v[112:115], a[104:107], v[180:183], v[112:115]
    v_fmac_f32 v240, v24, v241
    v_fmac_f32_dpp v240, -v241, v25 row_ror:8 row_mask:0xf bank_mask:0xf
    v_mfma_f32_16x16x32_bf16 v[116:119], a[108:111], v[180:183], v[116:119]
    v_fmac_f32 v239, v24, v240
    v_fmac_f32_dpp v239, -v240, v25 row_ror:8 row_mask:0xf bank_mask:0xf
    s_waitcnt lgkmcnt(4)
    v_mfma_f32_16x16x32_bf16 v[80:83], a[112:115], v[144:147], v[80:83]
    ds_read_b128 v[164:167], v6 offset:15360
    v_fmac_f32 v238, v24, v239
    v_fmac_f32_dpp v238, -v239, v25 row_ror:8 row_mask:0xf bank_mask:0xf
    v_mfma_f32_16x16x32_bf16 v[84:87], a[116:119], v[144:147], v[84:87]
    ds_read_b128 v[168:171], v6 offset:15744
    s_waitcnt lgkmcnt(4)
    v_fmac_f32 v237, v24, v238
    v_fmac_f32_dpp v237, -v238, v25 row_ror:8 row_mask:0xf bank_mask:0xf
    v_mfma_f32_16x16x32_bf16 v[88:91], a[112:115], v[148:151], v[88:91]
    ds_read_b128 v[172:175], v7 offset:15360
    v_fmac_f32 v236, v24, v237
    v_fmac_f32_dpp v236, -v237, v25 row_ror:8 row_mask:0xf bank_mask:0xf
    v_mfma_f32_16x16x32_bf16 v[92:95], a[116:119], v[148:151], v[92:95]
    ds_read_b128 v[176:179], v6 offset:16000
    v_fmac_f32 v235, v24, v236
    v_fmac_f32_dpp v235, -v236, v25 row_ror:8 row_mask:0xf bank_mask:0xf
    v_mfma_f32_16x16x32_bf16 v[96:99], a[112:115], v[152:155], v[96:99]
    ds_read_b128 v[180:183], v6 offset:16384
    v_fmac_f32 v234, v24, v235
    v_fmac_f32_dpp v234, -v235, v25 row_ror:8 row_mask:0xf bank_mask:0xf
    v_mfma_f32_16x16x32_bf16 v[100:103], a[116:119], v[152:155], v[100:103]
    s_waitcnt lgkmcnt(5)
    v_fmac_f32 v233, v24, v234
    v_fmac_f32_dpp v233, -v234, v25 row_ror:8 row_mask:0xf bank_mask:0xf
    v_mfma_f32_16x16x32_bf16 v[104:107], a[112:115], v[156:159], v[104:107]
    v_fmac_f32 v232, v24, v233
    v_fmac_f32_dpp v232, -v233, v25 row_ror:8 row_mask:0xf bank_mask:0xf
    v_mfma_f32_16x16x32_bf16 v[108:111], a[116:119], v[156:159], v[108:111]
    ds_write_b32 v143, v232
    v_mfma_f32_16x16x32_bf16 v[112:115], a[112:115], v[160:163], v[112:115]
    v_mfma_f32_16x16x32_bf16 v[116:119], a[116:119], v[160:163], v[116:119]
    s_waitcnt lgkmcnt(5)
    s_waitcnt lgkmcnt(1)
    s_waitcnt lgkmcnt(0)
    s_barrier
    v_mfma_f32_16x16x32_bf16 v[80:83], a[120:123], v[164:167], v[80:83]
    ds_read_b128 v[144:147], v6 offset:20480
    ds_read_b32 v232, v142 offset:0
    ds_read_b32 v233, v142 offset:1280
    ds_read_b32 v234, v142 offset:2560
    ds_read_b32 v235, v142 offset:3840
    s_cmp_lt_u32 s3, 2
    s_cbranch_scc0 L_skip_20
    s_add_u32 m0, s9, 0
    s_add_u32 s15, s38, 40960
    s_sub_u32 s31, s15, 51200
    s_min_u32 s15, s15, s31
    s_add_u32 s15, s15, s36
    buffer_load_dwordx4 v20, s[64:67], s15 offen offset:0 sc1 lds
    buffer_load_dwordx4 v20, s[64:67], s15 offen offset:1024 sc1 lds
    buffer_load_dwordx4 v20, s[64:67], s15 offen offset:2048 sc1 lds
    buffer_load_dwordx4 v20, s[64:67], s15 offen offset:3072 sc1 lds
    s_add_u32 m0, s9, 4096
    s_add_u32 s15, s15, 4096
    buffer_load_dwordx4 v20, s[64:67], s15 offen sc1 lds
L_skip_20:
    v_mfma_f32_16x16x32_bf16 v[84:87], a[124:127], v[164:167], v[84:87]
    ds_read_b128 v[148:151], v6 offset:20864
    ds_read_b32 v236, v142 offset:5120
    v_add_u32 v22, 4096, v20
    v_add_u32 v23, 8192, v20
    v_add_u32 v24, 12288, v20
    v_mfma_f32_16x16x32_bf16 v[88:91], a[120:123], v[168:171], v[88:91]
    ds_read_b128 v[152:155], v7 offset:20480
    v_lshlrev_b32 v25, 3, v1
    v_mfma_f32_16x16x32_bf16 v[92:95], a[124:127], v[168:171], v[92:95]
    ds_read_b128 v[156:159], v6 offset:21120
    v_mfma_f32_16x16x32_bf16 v[96:99], a[120:123], v[172:175], v[96:99]
    ds_read_b128 v[160:163], v6 offset:21504
    v_mfma_f32_16x16x32_bf16 v[100:103], a[124:127], v[172:175], v[100:103]
    s_waitcnt lgkmcnt(3)
    v_fmac_f32 v136, v196, v232
    v_fmac_f32 v137, v202, v233
    v_fmac_f32 v138, v208, v234
    v_fmac_f32 v139, v214, v235
    v_mfma_f32_16x16x32_bf16 v[104:107], a[120:123], v[176:179], v[104:107]
    v_fmac_f32 v140, v220, v236
    v_fmac_f32_dpp v136, v232, v197 row_ror:8 row_mask:0xf bank_mask:0xf
    v_fmac_f32_dpp v137, v233, v203 row_ror:8 row_mask:0xf bank_mask:0xf
    v_fmac_f32_dpp v138, v234, v209 row_ror:8 row_mask:0xf bank_mask:0xf
    v_fmac_f32_dpp v139, v235, v215 row_ror:8 row_mask:0xf bank_mask:0xf
    v_mfma_f32_16x16x32_bf16 v[108:111], a[124:127], v[176:179], v[108:111]
    v_fmac_f32_dpp v140, v236, v221 row_ror:8 row_mask:0xf bank_mask:0xf
    v_fmac_f32 v32, v192, v136
    v_fmac_f32_dpp v32, v136, v193 row_ror:8 row_mask:0xf bank_mask:0xf
    v_fmac_f32 v33, v192, v32
    s_nop 0
    v_fmac_f32_dpp v33, v32, v193 row_ror:8 row_mask:0xf bank_mask:0xf
    v_mfma_f32_16x16x32_bf16 v[112:115], a[120:123], v[180:183], v[112:115]
    v_fmac_f32 v34, v192, v33
    v_fmac_f32_dpp v34, v33, v193 row_ror:8 row_mask:0xf bank_mask:0xf
    v_fmac_f32 v35, v192, v34
    s_nop 0
    v_fmac_f32_dpp v35, v34, v193 row_ror:8 row_mask:0xf bank_mask:0xf
    v_mfma_f32_16x16x32_bf16 v[116:119], a[124:127], v[180:183], v[116:119]
    v_fmac_f32 v36, v192, v35
    v_fmac_f32_dpp v36, v35, v193 row_ror:8 row_mask:0xf bank_mask:0xf
    v_fmac_f32 v37, v192, v36
    s_nop 0
    v_fmac_f32_dpp v37, v36, v193 row_ror:8 row_mask:0xf bank_mask:0xf
    v_mfma_f32_16x16x32_bf16 v[80:83], a[128:131], v[144:147], v[80:83]
    ds_read_b128 v[164:167], v6 offset:25600
    v_fmac_f32 v38, v192, v37
    v_fmac_f32_dpp v38, v37, v193 row_ror:8 row_mask:0xf bank_mask:0xf
    v_fmac_f32 v39, v192, v38
    s_nop 0
    v_fmac_f32_dpp v39, v38, v193 row_ror:8 row_mask:0xf bank_mask:0xf
    v_mfma_f32_16x16x32_bf16 v[84:87], a[132:135], v[144:147], v[84:87]
    ds_read_b128 v[168:171], v6 offset:25984
    s_waitcnt lgkmcnt(4)
    v_fmac_f32 v40, v198, v137
    v_fmac_f32_dpp v40, v137, v199 row_ror:8 row_mask:0xf bank_mask:0xf
    v_cvt_pk_bf16_f32 v32, v32, v33
    v_mfma_f32_16x16x32_bf16 v[88:91], a[128:131], v[148:151], v[88:91]
    ds_read_b128 v[172:175], v7 offset:25600
    v_fmac_f32 v41, v198, v40
    v_fmac_f32_dpp v41, v40, v199 row_ror:8 row_mask:0xf bank_mask:0xf
    v_cvt_pk_bf16_f32 v33, v34, v35
    v_mfma_f32_16x16x32_bf16 v[92:95], a[132:135], v[148:151], v[92:95]
    ds_read_b128 v[176:179], v6 offset:26240
    v_fmac_f32 v42, v198, v41
    v_fmac_f32_dpp v42, v41, v199 row_ror:8 row_mask:0xf bank_mask:0xf
    v_cvt_pk_bf16_f32 v34, v36, v37
    v_mfma_f32_16x16x32_bf16 v[96:99], a[128:131], v[152:155], v[96:99]
    ds_read_b128 v[180:183], v6 offset:26624
    v_fmac_f32 v43, v198, v42
    v_fmac_f32_dpp v43, v42, v199 row_ror:8 row_mask:0xf bank_mask:0xf
    v_cvt_pk_bf16_f32 v35, v38, v39
    v_mfma_f32_16x16x32_bf16 v[100:103], a[132:135], v[152:155], v[100:103]
    s_waitcnt lgkmcnt(5)
    v_fmac_f32 v44, v198, v43
    v_fmac_f32_dpp v44, v43, v199 row_ror:8 row_mask:0xf bank_mask:0xf
    ds_write_b128 v187, v[32:35] offset:0
    v_mfma_f32_16x16x32_bf16 v[104:107], a[128:131], v[156:159], v[104:107]
    v_fmac_f32 v45, v198, v44
    v_fmac_f32_dpp v45, v44, v199 row_ror:8 row_mask:0xf bank_mask:0xf
    ds_read_b64_tr_b16 v[36:37], v188 offset:0
    v_fmac_f32 v46, v198, v45
    v_fmac_f32_dpp v46, v45, v199 row_ror:8 row_mask:0xf bank_mask:0xf
    v_mfma_f32_16x16x32_bf16 v[108:111], a[132:135], v[156:159], v[108:111]
    ds_read_b64_tr_b16 v[38:39], v188 offset:64
    v_fmac_f32 v47, v198, v46
    v_fmac_f32_dpp v47, v46, v199 row_ror:8 row_mask:0xf bank_mask:0xf
    v_fmac_f32 v48, v204, v138
    v_fmac_f32_dpp v48, v138, v205 row_ror:8 row_mask:0xf bank_mask:0xf
    v_mfma_f32_16x16x32_bf16 v[112:115], a[128:131], v[160:163], v[112:115]
    v_cvt_pk_bf16_f32 v40, v40, v41
    v_fmac_f32 v49, v204, v48
    v_fmac_f32_dpp v49, v48, v205 row_ror:8 row_mask:0xf bank_mask:0xf
    v_cvt_pk_bf16_f32 v41, v42, v43
    v_mfma_f32_16x16x32_bf16 v[116:119], a[132:135], v[160:163], v[116:119]
    v_fmac_f32 v50, v204, v49
    v_fmac_f32_dpp v50, v49, v205 row_ror:8 row_mask:0xf bank_mask:0xf
    v_cvt_pk_bf16_f32 v42, v44, v45
    v_fmac_f32 v51, v204, v50
    v_fmac_f32_dpp v51, v50, v205 row_ror:8 row_mask:0xf bank_mask:0xf
    s_waitcnt lgkmcnt(7)
    v_mfma_f32_16x16x32_bf16 v[80:83], a[136:139], v[164:167], v[80:83]
    ds_read_b128 v[144:147], v6 offset:30720
    v_cvt_pk_bf16_f32 v43, v46, v47
    v_fmac_f32 v52, v204, v51
    v_fmac_f32_dpp v52, v51, v205 row_ror:8 row_mask:0xf bank_mask:0xf
    s_waitcnt lgkmcnt(1)
    v_mfma_f32_16x16x32_bf16 v[84:87], a[140:143], v[164:167], v[84:87]
    ds_read_b128 v[148:151], v6 offset:31104
    buffer_store_dwordx4 v[36:39], v189, s[64:67], s96 offen offset:0 sc1
    v_mfma_f32_16x16x32_bf16 v[88:91], a[136:139], v[168:171], v[88:91]
    ds_read_b128 v[152:155], v7 offset:30720
    v_fmac_f32 v53, v204, v52
    v_fmac_f32_dpp v53, v52, v205 row_ror:8 row_mask:0xf bank_mask:0xf
    ds_write_b128 v187, v[40:43] offset:1024
    v_mfma_f32_16x16x32_bf16 v[92:95], a[140:143], v[168:171], v[92:95]
    ds_read_b128 v[156:159], v6 offset:31360
    v_fmac_f32 v54, v204, v53
    v_fmac_f32_dpp v54, v53, v205 row_ror:8 row_mask:0xf bank_mask:0xf
    ds_read_b64_tr_b16 v[44:45], v188 offset:1024
    v_mfma_f32_16x16x32_bf16 v[96:99], a[136:139], v[172:175], v[96:99]
    ds_read_b128 v[160:163], v6 offset:31744
    v_fmac_f32 v55, v204, v54
    v_fmac_f32_dpp v55, v54, v205 row_ror:8 row_mask:0xf bank_mask:0xf
    ds_read_b64_tr_b16 v[46:47], v188 offset:1088
    v_mfma_f32_16x16x32_bf16 v[100:103], a[140:143], v[172:175], v[100:103]
    v_fmac_f32 v56, v210, v139
    v_fmac_f32_dpp v56, v139, v211 row_ror:8 row_mask:0xf bank_mask:0xf
    v_cvt_pk_bf16_f32 v48, v48, v49
    v_fmac_f32 v57, v210, v56
    v_fmac_f32_dpp v57, v56, v211 row_ror:8 row_mask:0xf bank_mask:0xf
    v_mfma_f32_16x16x32_bf16 v[104:107], a[136:139], v[176:179], v[104:107]
    v_cvt_pk_bf16_f32 v49, v50, v51
    v_fmac_f32 v58, v210, v57
    v_fmac_f32_dpp v58, v57, v211 row_ror:8 row_mask:0xf bank_mask:0xf
    v_cvt_pk_bf16_f32 v50, v52, v53
    v_mfma_f32_16x16x32_bf16 v[108:111], a[140:143], v[176:179], v[108:111]
    v_fmac_f32 v59, v210, v58
    v_fmac_f32_dpp v59, v58, v211 row_ror:8 row_mask:0xf bank_mask:0xf
    v_cvt_pk_bf16_f32 v51, v54, v55
    v_fmac_f32 v60, v210, v59
    v_fmac_f32_dpp v60, v59, v211 row_ror:8 row_mask:0xf bank_mask:0xf
    v_mfma_f32_16x16x32_bf16 v[112:115], a[136:139], v[180:183], v[112:115]
    s_waitcnt lgkmcnt(0)
    buffer_store_dwordx4 v[44:47], v189, s[64:67], s96 offen offset:256 sc1
    v_mfma_f32_16x16x32_bf16 v[116:119], a[140:143], v[180:183], v[116:119]
    v_fmac_f32 v61, v210, v60
    v_fmac_f32_dpp v61, v60, v211 row_ror:8 row_mask:0xf bank_mask:0xf
    ds_write_b128 v187, v[48:51] offset:2048
    v_mfma_f32_16x16x32_bf16 v[80:83], a[144:147], v[144:147], v[80:83]
    ds_read_b128 v[164:167], v6 offset:35840
    v_fmac_f32 v62, v210, v61
    v_fmac_f32_dpp v62, v61, v211 row_ror:8 row_mask:0xf bank_mask:0xf
    ds_read_b64_tr_b16 v[52:53], v188 offset:2048
    v_mfma_f32_16x16x32_bf16 v[84:87], a[148:151], v[144:147], v[84:87]
    ds_read_b128 v[168:171], v6 offset:36224
    v_fmac_f32 v63, v210, v62
    v_fmac_f32_dpp v63, v62, v211 row_ror:8 row_mask:0xf bank_mask:0xf
    ds_read_b64_tr_b16 v[54:55], v188 offset:2112
    v_mfma_f32_16x16x32_bf16 v[88:91], a[144:147], v[148:151], v[88:91]
    ds_read_b128 v[172:175], v7 offset:35840
    v_fmac_f32 v64, v216, v140
    v_fmac_f32_dpp v64, v140, v217 row_ror:8 row_mask:0xf bank_mask:0xf
    v_cvt_pk_bf16_f32 v56, v56, v57
    v_mfma_f32_16x16x32_bf16 v[92:95], a[148:151], v[148:151], v[92:95]
    ds_read_b128 v[176:179], v6 offset:36480
    v_fmac_f32 v65, v216, v64
    v_fmac_f32_dpp v65, v64, v217 row_ror:8 row_mask:0xf bank_mask:0xf
    v_cvt_pk_bf16_f32 v57, v58, v59
    v_mfma_f32_16x16x32_bf16 v[96:99], a[144:147], v[152:155], v[96:99]
    ds_read_b128 v[180:183], v6 offset:36864
    v_fmac_f32 v66, v216, v65
    v_fmac_f32_dpp v66, v65, v217 row_ror:8 row_mask:0xf bank_mask:0xf
    v_cvt_pk_bf16_f32 v58, v60, v61
    v_mfma_f32_16x16x32_bf16 v[100:103], a[148:151], v[152:155], v[100:103]
    v_fmac_f32 v67, v216, v66
    v_fmac_f32_dpp v67, v66, v217 row_ror:8 row_mask:0xf bank_mask:0xf
    v_cvt_pk_bf16_f32 v59, v62, v63
    v_fmac_f32 v68, v216, v67
    v_fmac_f32_dpp v68, v67, v217 row_ror:8 row_mask:0xf bank_mask:0xf
    v_mfma_f32_16x16x32_bf16 v[104:107], a[144:147], v[156:159], v[104:107]
    s_waitcnt lgkmcnt(3)
    buffer_store_dwordx4 v[52:55], v189, s[64:67], s96 offen offset:512 sc1
    v_mfma_f32_16x16x32_bf16 v[108:111], a[148:151], v[156:159], v[108:111]
    v_fmac_f32 v69, v216, v68
    v_fmac_f32_dpp v69, v68, v217 row_ror:8 row_mask:0xf bank_mask:0xf
    ds_write_b128 v187, v[56:59] offset:3072
    v_mfma_f32_16x16x32_bf16 v[112:115], a[144:147], v[160:163], v[112:115]
    v_fmac_f32 v70, v216, v69
    v_fmac_f32_dpp v70, v69, v217 row_ror:8 row_mask:0xf bank_mask:0xf
    ds_read_b64_tr_b16 v[60:61], v188 offset:3072
    v_fmac_f32 v71, v216, v70
    v_fmac_f32_dpp v71, v70, v217 row_ror:8 row_mask:0xf bank_mask:0xf
    v_mfma_f32_16x16x32_bf16 v[116:119], a[148:151], v[160:163], v[116:119]
    ds_read_b64_tr_b16 v[62:63], v188 offset:3136
    v_cvt_pk_bf16_f32 v64, v64, v65
    v_cvt_pk_bf16_f32 v65, v66, v67
    v_cvt_pk_bf16_f32 v66, v68, v69
    v_cvt_pk_bf16_f32 v67, v70, v71
    s_waitcnt lgkmcnt(3)
    s_barrier
    v_mfma_f32_16x16x32_bf16 v[80:83], a[152:155], v[164:167], v[80:83]
    ds_read_b128 v[144:147], v8 offset:0
    s_waitcnt lgkmcnt(1)
    buffer_store_dwordx4 v[60:63], v189, s[64:67], s96 offen offset:768 sc1
    v_mfma_f32_16x16x32_bf16 v[84:87], a[156:159], v[164:167], v[84:87]
    ds_read_b128 v[148:151], v76
    v_add_u32 v76, v76, v77
    ds_write_b128 v187, v[64:67] offset:4096
    v_mfma_f32_16x16x32_bf16 v[88:91], a[152:155], v[168:171], v[88:91]
    ds_read_b128 v[152:155], v8 offset:384
    ds_read_b64_tr_b16 v[68:69], v188 offset:4096
    ds_read_b64_tr_b16 v[70:71], v188 offset:4160
    v_mfma_f32_16x16x32_bf16 v[92:95], a[156:159], v[168:171], v[92:95]
    v_mfma_f32_16x16x32_bf16 v[96:99], a[152:155], v[172:175], v[96:99]
    v_mfma_f32_16x16x32_bf16 v[100:103], a[156:159], v[172:175], v[100:103]
    v_mfma_f32_16x16x32_bf16 v[104:107], a[152:155], v[176:179], v[104:107]
    s_waitcnt lgkmcnt(0)
    buffer_store_dwordx4 v[68:71], v189, s[64:67], s96 offen offset:1024 sc1
    v_mfma_f32_16x16x32_bf16 v[108:111], a[156:159], v[176:179], v[108:111]
    v_mfma_f32_16x16x32_bf16 v[112:115], a[152:155], v[180:183], v[112:115]
    v_mfma_f32_16x16x32_bf16 v[116:119], a[156:159], v[180:183], v[116:119]
    v_mfma_f32_16x16x32_bf16 v[192:195], v[144:147], a[0:3], v[222:225]
    ds_read_b128 v[156:159], v8 offset:640
    v_cmp_gt_u32 vcc, 8, v2
    v_mov_b32 v28, 0x3f803f80
    v_cvt_pk_bf16_f32 v140, v96, v97
    v_cvt_pk_bf16_f32 v141, v98, v99
    v_cvt_pk_bf16_f32 v142, v100, v101
    v_cvt_pk_bf16_f32 v143, v102, v103
    v_cvt_pk_bf16_f32 v132, v104, v105
    v_cvt_pk_bf16_f32 v133, v106, v107
    v_cvt_pk_bf16_f32 v134, v108, v109
    v_cvt_pk_bf16_f32 v135, v110, v111
    v_cvt_pk_bf16_f32 v136, v112, v113
    v_cvt_pk_bf16_f32 v137, v114, v115
    v_cvt_pk_bf16_f32 v138, v116, v117
    v_cvt_pk_bf16_f32 v139, v118, v119
    v_cndmask_b32 v140, v140, v28, vcc
    v_cndmask_b32 v141, v141, v28, vcc
    v_cndmask_b32 v142, v142, v28, vcc
    v_cndmask_b32 v143, v143, v28, vcc
    s_mov_b32 s98, 0x0f550f55
    s_mov_b32 s99, 0x0f550f55
    v_cmp_gt_u32 vcc, 16, v1
    v_fma_f32 v232, v96, s94, v10
    v_fma_f32 v233, v97, s94, v10
    v_fma_f32 v234, v98, s94, v10
    v_fma_f32 v235, v99, s94, v10
    v_fma_f32 v236, v100, s94, v10
    v_fma_f32 v237, v101, s94, v10
    v_fma_f32 v238, v102, s94, v10
    v_fma_f32 v239, v103, s94, v10
    v_exp_f32 v232, v232 clamp
    v_max_f32 v96, s95, v96
    v_exp_f32 v233, v233 clamp
    v_max_f32 v97, s95, v97
    v_exp_f32 v234, v234 clamp
    v_max_f32 v98, s95, v98
    v_exp_f32 v235, v235 clamp
    v_max_f32 v99, s95, v99
    v_exp_f32 v236, v236 clamp
    v_max_f32 v100, s95, v100
    v_exp_f32 v237, v237 clamp
    v_mfma_f32_16x16x32_bf16 v[196:199], v[144:147], a[4:7], v[222:225]
    ds_read_b128 v[160:163], v76
    v_add_u32 v76, v76, v78
    v_max_f32 v101, s95, v101
    v_exp_f32 v238, v238 clamp
    v_max_f32 v102, s95, v102
    v_exp_f32 v239, v239 clamp
    v_max_f32 v103, s95, v103
    v_add_f32 v96, v96, v232
    v_add_f32 v97, v97, v233
    v_add_f32 v98, v98, v234
    v_add_f32 v99, v99, v235
    v_add_f32 v100, v100, v236
    v_add_f32 v101, v101, v237
    v_add_f32 v102, v102, v238
    v_add_f32 v103, v103, v239
    v_cvt_pk_bf16_f32 v128, v96, v97
    v_cvt_pk_bf16_f32 v129, v98, v99
    v_cvt_pk_bf16_f32 v130, v100, v101
    v_cvt_pk_bf16_f32 v131, v102, v103
    s_nop 1
    v_mfma_f32_16x16x32_bf16 v[104:107], v[128:131], v[132:135], 0
    v_mfma_f32_16x16x32_bf16 v[108:111], v[128:131], v[136:139], 0
    v_mfma_f32_16x16x32_bf16 v[112:115], v[128:131], v[140:143], 0
    v_fma_f32 v232, v80, s94, v10
    v_fma_f32 v233, v81, s94, v10
    v_fma_f32 v234, v82, s94, v10
    v_fma_f32 v235, v83, s94, v10
    v_fma_f32 v236, v84, s94, v10
    v_fma_f32 v237, v85, s94, v10
    v_fma_f32 v238, v86, s94, v10
    v_fma_f32 v239, v87, s94, v10
    v_exp_f32 v232, v232 clamp
    v_max_f32 v80, s95, v80
    v_exp_f32 v233, v233 clamp
    v_max_f32 v81, s95, v81
    v_exp_f32 v234, v234 clamp
    v_max_f32 v82, s95, v82
    v_exp_f32 v235, v235 clamp
    s_add_u32 m0, s8, 12288
    s_nop 0
    buffer_load_dwordx4 v13, s[48:51], 0 offen offset:0 lds
    v_mfma_f32_16x16x32_bf16 v[200:203], v[148:151], a[0:3], v[222:225]
    ds_read_b128 v[164:167], v8 offset:1024
    v_max_f32 v83, s95, v83
    v_exp_f32 v236, v236 clamp
    v_max_f32 v84, s95, v84
    v_exp_f32 v237, v237 clamp
    v_max_f32 v85, s95, v85
    v_exp_f32 v238, v238 clamp
    v_max_f32 v86, s95, v86
    v_exp_f32 v239, v239 clamp
    v_max_f32 v87, s95, v87
    v_add_f32 v80, v80, v232
    v_add_f32 v81, v81, v233
    v_add_f32 v82, v82, v234
    v_add_f32 v83, v83, v235
    v_add_f32 v84, v84, v236
    v_add_f32 v85, v85, v237
    v_add_f32 v86, v86, v238
    v_add_f32 v87, v87, v239
    v_cvt_pk_bf16_f32 v120, v80, v81
    v_cvt_pk_bf16_f32 v121, v82, v83
    v_cvt_pk_bf16_f32 v122, v84, v85
    v_cvt_pk_bf16_f32 v123, v86, v87
    s_nop 1
    v_mfma_f32_16x16x32_bf16 v[116:119], v[120:123], v[132:135], 0
    v_mfma_f32_16x16x32_bf16 v[96:99], v[120:123], v[140:143], 0
    v_cndmask_b32 v104, v108, v104, vcc
    v_cndmask_b32 v105, v109, v105, vcc
    v_cndmask_b32 v106, v110, v106, vcc
    v_cndmask_b32 v107, v111, v107, vcc
    v_permlane32_swap_b32 v104, v112
    v_permlane32_swap_b32 v105, v113
    v_permlane32_swap_b32 v106, v114
    v_permlane32_swap_b32 v107, v115
    ds_write_b128 v191, v[104:107] offset:3072
    ds_write_b128 v191, v[116:119]
    v_fma_f32 v232, v88, s94, v10
    v_fma_f32 v233, v89, s94, v10
    buffer_load_dwordx4 v14, s[48:51], 0 offen offset:1024 lds
    v_mfma_f32_16x16x32_bf16 v[204:207], v[148:151], a[4:7], v[222:225]
    v_fma_f32 v234, v90, s94, v10
    v_fma_f32 v235, v91, s94, v10
    v_fma_f32 v236, v92, s94, v10
    v_fma_f32 v237, v93, s94, v10
    v_fma_f32 v238, v94, s94, v10
    v_fma_f32 v239, v95, s94, v10
    v_exp_f32 v232, v232 clamp
    v_max_f32 v88, s95, v88
    v_exp_f32 v233, v233 clamp
    v_max_f32 v89, s95, v89
    v_exp_f32 v234, v234 clamp
    v_max_f32 v90, s95, v90
    v_exp_f32 v235, v235 clamp
    v_max_f32 v91, s95, v91
    v_exp_f32 v236, v236 clamp
    v_max_f32 v92, s95, v92
    v_exp_f32 v237, v237 clamp
    v_max_f32 v93, s95, v93
    v_exp_f32 v238, v238 clamp
    v_max_f32 v94, s95, v94
    v_exp_f32 v239, v239 clamp
    v_max_f32 v95, s95, v95
    v_add_f32 v88, v88, v232
    v_add_f32 v89, v89, v233
    v_add_f32 v90, v90, v234
    v_add_f32 v91, v91, v235
    v_add_f32 v92, v92, v236
    v_add_f32 v93, v93, v237
    v_add_f32 v94, v94, v238
    v_add_f32 v95, v95, v239
    v_cvt_pk_bf16_f32 v124, v88, v89
    v_cvt_pk_bf16_f32 v125, v90, v91
    v_cvt_pk_bf16_f32 v126, v92, v93
    v_cvt_pk_bf16_f32 v127, v94, v95
    s_nop 1
    v_mfma_f32_16x16x32_bf16 v[80:83], v[124:127], v[140:143], 0
    v_mfma_f32_16x16x32_bf16 v[100:103], v[124:127], v[136:139], 0
    buffer_load_dwordx4 v19, s[48:51], 0 offen offset:2048 lds
    v_mfma_f32_16x16x32_bf16 v[208:211], v[152:155], a[0:3], v[222:225]
    v_mfma_f32_16x16x32_bf16 v[212:215], v[152:155], a[4:7], v[222:225]
    s_nop 3
    v_cndmask_b32 v96, v80, v96, s[98:99]
    v_cndmask_b32 v97, v81, v97, s[98:99]
    v_cndmask_b32 v98, v82, v98, s[98:99]
    v_cndmask_b32 v99, v83, v99, s[98:99]
    ds_write_b128 v191, v[100:103] offset:1024
    ds_write_b128 v191, v[96:99] offset:2048
    s_lshl_b32 s11, s3, 10
    s_add_u32 s11, s11, 20480
    v_add_u32 v191, s11, v20
    s_waitcnt lgkmcnt(0)
    s_barrier
    v_mfma_f32_16x16x32_bf16 v[192:195], v[156:159], a[8:11], v[192:195]
    ds_read_b128 v[144:147], v8 offset:5120
    s_waitcnt vmcnt(3)
    s_mov_b64 exec, 1
    buffer_atomic_add v27, off, s[64:67], s39 sc1
    s_mov_b64 exec, -1
    ds_read_b128 a[0:3], v4 offset:0
    ds_read_b128 a[4:7], v5 offset:0
    v_mfma_f32_16x16x32_bf16 v[196:199], v[156:159], a[12:15], v[196:199]
    ds_read_b128 v[148:151], v76
    v_add_u32 v76, v76, v77
    ds_read_b128 v[80:83], v191 offset:0
    ds_read_b128 v[84:87], v191 offset:4096
    v_mfma_f32_16x16x32_bf16 v[200:203], v[160:163], a[8:11], v[200:203]
    ds_read_b128 v[152:155], v8 offset:5504
    ds_read_b128 v[88:91], v191 offset:8192
    ds_read_b128 v[92:95], v191 offset:12288
    s_waitcnt lgkmcnt(6)
    s_add_u32 m0, s8, 0
    s_mov_b32 s15, 61824
    buffer_load_dwordx4 v184, s[60:63], s15 offen offset:0 lds
    v_mfma_f32_16x16x32_bf16 v[204:207], v[160:163], a[12:15], v[204:207]
    v_mfma_f32_16x16x32_bf16 v[208:211], v[164:167], a[8:11], v[208:211]
    buffer_load_dwordx4 v185, s[60:63], s15 offen offset:1024 lds
    v_mfma_f32_16x16x32_bf16 v[212:215], v[164:167], a[12:15], v[212:215]
    v_mfma_f32_16x16x32_bf16 v[192:195], v[144:147], a[16:19], v[192:195]
    ds_read_b128 v[156:159], v8 offset:5760
    s_waitcnt lgkmcnt(1)
    v_add_f32 v80, v80, v84
    v_add_f32 v88, v88, v92
    ds_read_b128 a[8:11], v4 offset:2048
    ds_read_b128 a[12:15], v5 offset:2048
    v_mfma_f32_16x16x32_bf16 v[196:199], v[144:147], a[20:23], v[196:199]
    ds_read_b128 v[160:163], v76
    v_add_u32 v76, v76, v78
    v_add_f32 v81, v81, v85
    v_add_f32 v89, v89, v93
    v_mfma_f32_16x16x32_bf16 v[200:203], v[148:151], a[16:19], v[200:203]
    ds_read_b128 v[164:167], v8 offset:6144
    v_add_f32 v82, v82, v86
    v_add_f32 v90, v90, v94
    v_add_f32 v83, v83, v87
    s_waitcnt lgkmcnt(2)
    s_add_u32 m0, s8, 2048
    s_mov_b32 s15, 82304
    buffer_load_dwordx4 v184, s[60:63], s15 offen offset:0 lds
    v_mfma_f32_16x16x32_bf16 v[204:207], v[148:151], a[20:23], v[204:207]
    v_add_f32 v91, v91, v95
    v_add_f32 v80, v80, v88
    v_add_f32 v81, v81, v89
    v_add_f32 v82, v82, v90
    v_mfma_f32_16x16x32_bf16 v[208:211], v[152:155], a[16:19], v[208:211]
    v_add_f32 v83, v83, v91
    v_cvt_pk_bf16_f32 v80, v80, v81
    v_cvt_pk_bf16_f32 v81, v82, v83
    v_min_u32 v80, -2, v80
    buffer_load_dwordx4 v185, s[60:63], s15 offen offset:1024 lds
    v_mfma_f32_16x16x32_bf16 v[212:215], v[152:155], a[20:23], v[212:215]
    v_min_u32 v81, -2, v81
    buffer_store_dwordx2 v[80:81], v25, s[64:67], s35 offen sc1
    s_waitcnt vmcnt(6)
    ds_read_b64_tr_b16 v[34:35], v230 offset:12288
    ds_read_b64_tr_b16 v[38:39], v230 offset:12320
    ds_read_b64_tr_b16 v[42:43], v230 offset:12352
    ds_read_b64_tr_b16 v[46:47], v230 offset:12384
    ds_read_b64_tr_b16 v[50:51], v230 offset:12416
    ds_read_u16 v52, v231 offset:0
    ds_read_u16 v53, v231 offset:32
    ds_read_u16 v54, v231 offset:64
    ds_read_u16 v55, v231 offset:96
    ds_read_u16 v56, v231 offset:128
    v_mfma_f32_16x16x32_bf16 v[192:195], v[156:159], a[24:27], v[192:195]
    ds_read_b128 v[144:147], v8 offset:10240
    ds_read_b128 a[16:19], v4 offset:4096
    ds_read_b128 a[20:23], v5 offset:4096
    v_mfma_f32_16x16x32_bf16 v[196:199], v[156:159], a[28:31], v[196:199]
    ds_read_b128 v[148:151], v76
    v_add_u32 v76, v76, v77
    s_waitcnt lgkmcnt(14)
    v_mfma_f32_16x16x32_bf16 v[200:203], v[160:163], a[24:27], v[200:203]
    ds_read_b128 v[152:155], v8 offset:10624
    v_mfma_f32_16x16x32_bf16 v[204:207], v[160:163], a[28:31], v[204:207]
    v_mfma_f32_16x16x32_bf16 v[208:211], v[164:167], a[24:27], v[208:211]
    s_waitcnt lgkmcnt(2)
    s_add_u32 m0, s8, 4096
    s_mov_b32 s15, 512
    buffer_load_dwordx4 v184, s[60:63], s15 offen offset:0 lds
    v_mfma_f32_16x16x32_bf16 v[212:215], v[164:167], a[28:31], v[212:215]
    v_mfma_f32_16x16x32_bf16 v[192:195], v[144:147], a[32:35], v[192:195]
    ds_read_b128 v[156:159], v8 offset:10880
    ds_read_b128 a[24:27], v4 offset:6144
    ds_read_b128 a[28:31], v5 offset:6144
    v_mfma_f32_16x16x32_bf16 v[196:199], v[144:147], a[36:39], v[196:199]
    ds_read_b128 v[160:163], v76
    v_add_u32 v76, v76, v78
    s_waitcnt lgkmcnt(4)
    buffer_load_dwordx4 v185, s[60:63], s15 offen offset:1024 lds
    v_mfma_f32_16x16x32_bf16 v[200:203], v[148:151], a[32:35], v[200:203]
    ds_read_b128 v[164:167], v8 offset:11264
    v_mfma_f32_16x16x32_bf16 v[204:207], v[148:151], a[36:39], v[204:207]
    v_mfma_f32_16x16x32_bf16 v[208:211], v[152:155], a[32:35], v[208:211]
    s_waitcnt lgkmcnt(2)
    s_add_u32 m0, s8, 6144
    s_mov_b32 s15, 20992
    buffer_load_dwordx4 v184, s[60:63], s15 offen offset:0 lds
    v_mfma_f32_16x16x32_bf16 v[212:215], v[152:155], a[36:39], v[212:215]
    v_mfma_f32_16x16x32_bf16 v[192:195], v[156:159], a[40:43], v[192:195]
    ds_read_b128 v[144:147], v8 offset:15360
    v_lshrrev_b32 v29, 3, v2
    ds_read_b128 a[32:35], v4 offset:8192
    ds_read_b128 a[36:39], v5 offset:8192
    v_mfma_f32_16x16x32_bf16 v[196:199], v[156:159], a[44:47], v[196:199]
    ds_read_b128 v[148:151], v76
    v_add_u32 v76, v76, v77
    s_waitcnt lgkmcnt(4)
    buffer_load_dwordx4 v185, s[60:63], s15 offen offset:1024 lds
    v_mfma_f32_16x16x32_bf16 v[200:203], v[160:163], a[40:43], v[200:203]
    ds_read_b128 v[152:155], v8 offset:15744
    v_xor_b32 v29, v29, v3
    v_mfma_f32_16x16x32_bf16 v[204:207], v[160:163], a[44:47], v[204:207]
    v_and_b32 v29, 1, v29
    v_lshlrev_b32 v29, 3, v29
    v_mfma_f32_16x16x32_bf16 v[208:211], v[164:167], a[40:43], v[208:211]
    v_bfe_u32 v30, v2, 1, 2
    v_or_b32 v29, v29, v30
    s_waitcnt lgkmcnt(2)
    s_add_u32 m0, s8, 8192
    s_mov_b32 s15, 41472
    buffer_load_dwordx4 v184, s[60:63], s15 offen offset:0 lds
    v_mfma_f32_16x16x32_bf16 v[212:215], v[164:167], a[44:47], v[212:215]
    v_and_b32 v30, 1, v2
    v_lshlrev_b32 v30, 4, v30
    v_mfma_f32_16x16x32_bf16 v[192:195], v[144:147], a[48:51], v[192:195]
    ds_read_b128 v[156:159], v8 offset:16000
    v_mov_b32 v31, 0x3f80
    ds_read_b128 a[40:43], v4 offset:10240
    ds_read_b128 a[44:47], v5 offset:10240
    buffer_load_dwordx4 v185, s[60:63], s15 offen offset:1024 lds
    v_mfma_f32_16x16x32_bf16 v[196:199], v[144:147], a[52:55], v[196:199]
    ds_read_b128 v[160:163], v76
    v_add_u32 v76, v76, v78
    s_waitcnt lgkmcnt(4)
    v_mfma_f32_16x16x32_bf16 v[200:203], v[148:151], a[48:51], v[200:203]
    ds_read_b128 v[164:167], v8 offset:16384
    v_lshlrev_b32 v31, v30, v31
    v_mfma_f32_16x16x32_bf16 v[204:207], v[148:151], a[52:55], v[204:207]
    v_cmp_eq_u32 vcc, 0, v29
    s_nop 1
    v_cndmask_b32 v216, 0, v31, vcc
    s_waitcnt lgkmcnt(2)
    s_add_u32 m0, s8, 10240
    s_mov_b32 s15, 61952
    buffer_load_dwordx4 v184, s[60:63], s15 offen offset:0 lds
    v_mfma_f32_16x16x32_bf16 v[208:211], v[152:155], a[48:51], v[208:211]
    v_cmp_eq_u32 vcc, 1, v29
    s_nop 1
    v_cndmask_b32 v217, 0, v31, vcc
    v_mfma_f32_16x16x32_bf16 v[212:215], v[152:155], a[52:55], v[212:215]
    v_cmp_eq_u32 vcc, 2, v29
    s_nop 1
    v_cndmask_b32 v218, 0, v31, vcc
    buffer_load_dwordx4 v185, s[60:63], s15 offen offset:1024 lds
    s_waitcnt lgkmcnt(0)
    s_barrier
    v_mfma_f32_16x16x32_bf16 v[192:195], v[156:159], a[56:59], v[192:195]
    ds_read_b128 v[144:147], v8 offset:20480
    s_waitcnt vmcnt(11)
    ds_read_b128 a[48:51], v4 offset:0
    ds_read_b128 a[52:55], v5 offset:0
    buffer_load_dword v26, off, s[64:67], s40 offset:0 sc1
    v_mfma_f32_16x16x32_bf16 v[196:199], v[156:159], a[60:63], v[196:199]
    ds_read_b128 v[148:151], v76
    v_add_u32 v76, v76, v77
    s_add_u32 s15, s28, 81920
    s_add_u32 m0, s8, 12288
    s_nop 0
    buffer_load_dwordx4 v20, s[64:67], s15 offen offset:0 sc1 lds
    v_mfma_f32_16x16x32_bf16 v[200:203], v[160:163], a[56:59], v[200:203]
    ds_read_b128 v[152:155], v8 offset:20864
    v_mfma_f32_16x16x32_bf16 v[204:207], v[160:163], a[60:63], v[204:207]
    v_cmp_eq_u32 vcc, 3, v29
    s_nop 1
    v_cndmask_b32 v219, 0, v31, vcc
    buffer_load_dwordx4 v20, s[64:67], s15 offen offset:1024 sc1 lds
    v_mfma_f32_16x16x32_bf16 v[208:211], v[164:167], a[56:59], v[208:211]
    v_and_b32 v29, 2, v3
    v_lshlrev_b32 v29, 7, v29
    v_mfma_f32_16x16x32_bf16 v[212:215], v[164:167], a[60:63], v[212:215]
    v_lshl_add_u32 v29, v2, 4, v29
    v_and_b32 v30, 1, v3
    s_waitcnt lgkmcnt(4)
    v_mfma_f32_16x16x32_bf16 v[192:195], v[144:147], a[64:67], v[192:195]
    ds_read_b128 v[156:159], v8 offset:21120
    v_lshl_add_u32 v29, v30, 3, v29
    s_waitcnt vmcnt(12)
    ds_read_b128 a[56:59], v4 offset:2048
    ds_read_b128 a[60:63], v5 offset:2048
    buffer_load_dwordx4 v20, s[64:67], s15 offen offset:2048 sc1 lds
    v_mfma_f32_16x16x32_bf16 v[196:199], v[144:147], a[68:71], v[196:199]
    ds_read_b128 v[160:163], v76
    v_add_u32 v76, v76, v78
    s_waitcnt lgkmcnt(4)
    v_mfma_f32_16x16x32_bf16 v[200:203], v[148:151], a[64:67], v[200:203]
    ds_read_b128 v[164:167], v8 offset:21504
    buffer_load_dwordx4 v20, s[64:67], s15 offen offset:3072 sc1 lds
    v_mfma_f32_16x16x32_bf16 v[204:207], v[148:151], a[68:71], v[204:207]
    s_lshl_b32 s11, s3, 9
    s_add_u32 s11, s11, 154112
    v_add_u32 v222, s11, v29
    v_mfma_f32_16x16x32_bf16 v[208:211], v[152:155], a[64:67], v[208:211]
    v_mfma_f32_16x16x32_bf16 v[212:215], v[152:155], a[68:71], v[212:215]
    s_waitcnt lgkmcnt(4)
    v_mfma_f32_16x16x32_bf16 v[192:195], v[156:159], a[72:75], v[192:195]
    ds_read_b128 v[144:147], v8 offset:25600
    s_waitcnt vmcnt(11)
    ds_read_b128 a[64:67], v4 offset:4096
    ds_read_b128 a[68:71], v5 offset:4096
    s_add_u32 m0, s8, 16384
    s_nop 0
    buffer_load_dwordx4 v22, s[64:67], s15 offen sc1 lds
    v_mfma_f32_16x16x32_bf16 v[196:199], v[156:159], a[76:79], v[196:199]
    ds_read_b128 v[148:151], v76
    v_add_u32 v76, v76, v77
    s_waitcnt lgkmcnt(4)
    v_mfma_f32_16x16x32_bf16 v[200:203], v[160:163], a[72:75], v[200:203]
    ds_read_b128 v[152:155], v8 offset:25984
    v_lshlrev_b32 v52, 16, v52
    s_add_u32 m0, s8, 0
    s_mov_b32 s15, 82432
    buffer_load_dwordx4 v184, s[60:63], s15 offen offset:0 lds
    v_mfma_f32_16x16x32_bf16 v[204:207], v[160:163], a[76:79], v[204:207]
    v_lshlrev_b32 v53, 16, v53
    v_lshlrev_b32 v54, 16, v54
    v_mfma_f32_16x16x32_bf16 v[208:211], v[164:167], a[72:75], v[208:211]
    v_lshlrev_b32 v55, 16, v55
    v_lshlrev_b32 v56, 16, v56
    buffer_load_dwordx4 v185, s[60:63], s15 offen offset:1024 lds
    v_mfma_f32_16x16x32_bf16 v[212:215], v[164:167], a[76:79], v[212:215]
    v_lshlrev_b32 v32, 16, v34
    v_and_b32 v33, 0xffff0000, v34
    s_waitcnt lgkmcnt(4)
    v_mfma_f32_16x16x32_bf16 v[192:195], v[144:147], a[80:83], v[192:195]
    ds_read_b128 v[156:159], v8 offset:26240
    v_lshlrev_b32 v34, 16, v35
    s_waitcnt vmcnt(12)
    ds_read_b128 a[72:75], v4 offset:6144
    ds_read_b128 a[76:79], v5 offset:6144
    v_mfma_f32_16x16x32_bf16 v[196:199], v[144:147], a[84:87], v[196:199]
    ds_read_b128 v[160:163], v76
    v_add_u32 v76, v76, v78
    s_waitcnt lgkmcnt(4)
    s_add_u32 s15, s28, 0
    s_add_u32 m0, s9, 40960
    s_nop 0
    buffer_load_dwordx4 v20, s[64:67], s15 offen offset:0 sc1 lds
    v_mfma_f32_16x16x32_bf16 v[200:203], v[148:151], a[80:83], v[200:203]
    ds_read_b128 v[164:167], v8 offset:26624
    v_and_b32 v35, 0xffff0000, v35
    v_mfma_f32_16x16x32_bf16 v[204:207], v[148:151], a[84:87], v[204:207]
    v_mul_f32 v32, v32, v52
    v_mul_f32 v33, v33, v52
    buffer_load_dwordx4 v20, s[64:67], s15 offen offset:1024 sc1 lds
    v_mfma_f32_16x16x32_bf16 v[208:211], v[152:155], a[80:83], v[208:211]
    v_mul_f32 v34, v34, v52
    v_mul_f32 v35, v35, v52
    v_mfma_f32_16x16x32_bf16 v[212:215], v[152:155], a[84:87], v[212:215]
    v_lshlrev_b32 v36, 16, v38
    v_and_b32 v37, 0xffff0000, v38
    s_waitcnt lgkmcnt(4)
    v_mfma_f32_16x16x32_bf16 v[192:195], v[156:159], a[88:91], v[192:195]
    ds_read_b128 v[144:147], v8 offset:30720
    v_lshlrev_b32 v38, 16, v39
    s_waitcnt vmcnt(12)
    ds_read_b128 a[80:83], v4 offset:8192
    ds_read_b128 a[84:87], v5 offset:8192
    v_mfma_f32_16x16x32_bf16 v[196:199], v[156:159], a[92:95], v[196:199]
    ds_read_b128 v[148:151], v76
    v_add_u32 v76, v76, v77
    s_waitcnt lgkmcnt(4)
    buffer_load_dwordx4 v20, s[64:67], s15 offen offset:2048 sc1 lds
    v_mfma_f32_16x16x32_bf16 v[200:203], v[160:163], a[88:91], v[200:203]
    ds_read_b128 v[152:155], v8 offset:31104
    v_and_b32 v39, 0xffff0000, v39
    v_mfma_f32_16x16x32_bf16 v[204:207], v[160:163], a[92:95], v[204:207]
    v_mul_f32 v36, v36, v53
    v_mul_f32 v37, v37, v53
    v_mfma_f32_16x16x32_bf16 v[208:211], v[164:167], a[88:91], v[208:211]
    v_mul_f32 v38, v38, v53
    v_mul_f32 v39, v39, v53
    buffer_load_dwordx4 v20, s[64:67], s15 offen offset:3072 sc1 lds
    v_mfma_f32_16x16x32_bf16 v[212:215], v[164:167], a[92:95], v[212:215]
    v_lshlrev_b32 v40, 16, v42
    v_and_b32 v41, 0xffff0000, v42
    s_waitcnt lgkmcnt(4)
    v_mfma_f32_16x16x32_bf16 v[192:195], v[144:147], a[96:99], v[192:195]
    ds_read_b128 v[156:159], v8 offset:31360
    v_lshlrev_b32 v42, 16, v43
    s_waitcnt vmcnt(12)
    ds_read_b128 a[88:91], v4 offset:10240
    ds_read_b128 a[92:95], v5 offset:10240
    v_mfma_f32_16x16x32_bf16 v[196:199], v[144:147], a[100:103], v[196:199]
    ds_read_b128 v[160:163], v76
    v_add_u32 v76, v76, v78
    s_waitcnt lgkmcnt(4)
    s_add_u32 m0, s9, 45056
    s_nop 0
    buffer_load_dwordx4 v22, s[64:67], s15 offen sc1 lds
    v_mfma_f32_16x16x32_bf16 v[200:203], v[148:151], a[96:99], v[200:203]
    ds_read_b128 v[164:167], v8 offset:31744
    v_and_b32 v43, 0xffff0000, v43
    v_mfma_f32_16x16x32_bf16 v[204:207], v[148:151], a[100:103], v[204:207]
    v_mul_f32 v40, v40, v54
    v_mul_f32 v41, v41, v54
    v_mfma_f32_16x16x32_bf16 v[208:211], v[152:155], a[96:99], v[208:211]
    v_mul_f32 v42, v42, v54
    v_mul_f32 v43, v43, v54
    buffer_load_dwordx4 v[80:83], v20, s[64:67], s25 offen offset:0 sc1
    v_mfma_f32_16x16x32_bf16 v[212:215], v[152:155], a[100:103], v[212:215]
    v_lshlrev_b32 v44, 16, v46
    v_and_b32 v45, 0xffff0000, v46
    s_waitcnt lgkmcnt(4)
    v_mfma_f32_16x16x32_bf16 v[192:195], v[156:159], a[104:107], v[192:195]
    ds_read_b128 v[144:147], v8 offset:35840
    v_lshlrev_b32 v46, 16, v47
    v_mfma_f32_16x16x32_bf16 v[196:199], v[156:159], a[108:111], v[196:199]
    ds_read_b128 v[148:151], v76
    v_add_u32 v76, v76, v77
    s_waitcnt lgkmcnt(2)
    buffer_load_dwordx4 v[84:87], v20, s[64:67], s25 offen offset:1024 sc1
    v_mfma_f32_16x16x32_bf16 v[200:203], v[160:163], a[104:107], v[200:203]
    ds_read_b128 v[152:155], v8 offset:36224
    v_and_b32 v47, 0xffff0000, v47
    s_waitcnt vmcnt(14)
    v_readfirstlane_b32 s29, v26
    s_nop 0
    s_cmp_ge_u32 s29, 32
    s_cbranch_scc0 L_slow_16
L_back_17:
    v_mfma_f32_16x16x32_bf16 v[204:207], v[160:163], a[108:111], v[204:207]
    v_mul_f32 v44, v44, v55
    v_mul_f32 v45, v45, v55
    buffer_load_dwordx4 v[88:91], v20, s[64:67], s25 offen offset:2048 sc1
    v_mfma_f32_16x16x32_bf16 v[208:211], v[164:167], a[104:107], v[208:211]
    v_mul_f32 v46, v46, v55
    v_mul_f32 v47, v47, v55
    v_mfma_f32_16x16x32_bf16 v[212:215], v[164:167], a[108:111], v[212:215]
    v_lshlrev_b32 v48, 16, v50
    v_and_b32 v49, 0xffff0000, v50
    s_waitcnt lgkmcnt(2)
    v_mfma_f32_16x16x32_bf16 v[192:195], v[144:147], a[112:115], v[192:195]
    ds_read_b128 v[156:159], v8 offset:36480
    v_lshlrev_b32 v50, 16, v51
    buffer_load_dwordx4 v[92:95], v20, s[64:67], s25 offen offset:3072 sc1
    v_mfma_f32_16x16x32_bf16 v[196:199], v[144:147], a[116:119], v[196:199]
    ds_read_b128 v[160:163], v76
    v_add_u32 v76, v76, v79
    s_waitcnt lgkmcnt(2)
    v_mfma_f32_16x16x32_bf16 v[200:203], v[148:151], a[112:115], v[200:203]
    ds_read_b128 v[164:167], v8 offset:36864
    v_and_b32 v51, 0xffff0000, v51
    v_mfma_f32_16x16x32_bf16 v[204:207], v[148:151], a[116:119], v[204:207]
    v_mul_f32 v48, v48, v56
    v_mul_f32 v49, v49, v56
    buffer_load_dwordx4 v[96:99], v22, s[64:67], s25 offen offset:0 sc1
    v_mfma_f32_16x16x32_bf16 v[208:211], v[152:155], a[112:115], v[208:211]
    v_mul_f32 v50, v50, v56
    v_mul_f32 v51, v51, v56
    v_mfma_f32_16x16x32_bf16 v[212:215], v[152:155], a[116:119], v[212:215]
    s_waitcnt lgkmcnt(2)
    s_waitcnt lgkmcnt(0)
    s_barrier
    v_mfma_f32_16x16x32_bf16 v[192:195], v[156:159], a[120:123], v[192:195]
    ds_read_b128 v[144:147], v6 offset:0
    s_waitcnt vmcnt(10)
    ds_read_b128 a[96:99], v4 offset:0
    ds_read_b128 a[100:103], v5 offset:0
    buffer_load_dwordx4 v[100:103], v22, s[64:67], s25 offen offset:1024 sc1
    v_mfma_f32_16x16x32_bf16 v[196:199], v[156:159], a[124:127], v[196:199]
    ds_read_b128 v[148:151], v76
    v_add_u32 v76, v76, v77
    v_mfma_f32_16x16x32_bf16 v[200:203], v[160:163], a[120:123], v[200:203]
    ds_read_b128 v[152:155], v6 offset:384
    buffer_load_dwordx4 v[104:107], v22, s[64:67], s25 offen offset:2048 sc1
    v_mfma_f32_16x16x32_bf16 v[204:207], v[160:163], a[124:127], v[204:207]
    v_mfma_f32_16x16x32_bf16 v[208:211], v[164:167], a[120:123], v[208:211]
    v_mfma_f32_16x16x32_bf16 v[212:215], v[164:167], a[124:127], v[212:215]
    s_waitcnt lgkmcnt(4)
    v_mfma_f32_16x16x32_bf16 v[192:195], v[144:147], a[128:131], v[192:195]
    ds_read_b128 v[156:159], v6 offset:640
    buffer_load_dwordx4 v[108:111], v22, s[64:67], s25 offen offset:3072 sc1
    v_mfma_f32_16x16x32_bf16 v[196:199], v[144:147], a[132:135], v[196:199]
    ds_read_b128 v[160:163], v76
    v_add_u32 v76, v76, v78
    s_waitcnt lgkmcnt(2)
    v_mfma_f32_16x16x32_bf16 v[200:203], v[148:151], a[128:131], v[200:203]
    ds_read_b128 v[164:167], v6 offset:1024
    v_mfma_f32_16x16x32_bf16 v[204:207], v[148:151], a[132:135], v[204:207]
    buffer_load_dwordx4 v[112:115], v20, s[64:67], s90 offen offset:0 sc1
    v_mfma_f32_16x16x32_bf16 v[208:211], v[152:155], a[128:131], v[208:211]
    v_mfma_f32_16x16x32_bf16 v[212:215], v[152:155], a[132:135], v[212:215]
    s_waitcnt lgkmcnt(2)
    v_mfma_f32_16x16x32_bf16 v[192:195], v[156:159], a[136:139], v[192:195]
    ds_read_b128 v[144:147], v6 offset:5120
    s_waitcnt vmcnt(8)
    v_mfma_f32_16x16x32_bf16 v[196:199], v[156:159], a[140:143], v[196:199]
    ds_read_b128 v[148:151], v76
    v_add_u32 v76, v76, v77
    s_waitcnt lgkmcnt(2)
    buffer_load_dwordx4 v[116:119], v20, s[64:67], s91 offen offset:0 sc1
    v_mfma_f32_16x16x32_bf16 v[200:203], v[160:163], a[136:139], v[200:203]
    ds_read_b128 v[152:155], v6 offset:5504
    v_mfma_f32_16x16x32_bf16 v[224:227], v[216:219], v[80:83], 0
    v_mfma_f32_16x16x32_bf16 v[204:207], v[160:163], a[140:143], v[204:207]
    s_waitcnt vmcnt(8)
    v_mfma_f32_16x16x32_bf16 v[224:227], v[216:219], v[84:87], v[224:227]
    buffer_load_dwordx4 v[120:123], v20, s[64:67], s92 offen offset:0 sc1
    v_mfma_f32_16x16x32_bf16 v[208:211], v[164:167], a[136:139], v[208:211]
    s_waitcnt vmcnt(8)
    v_mfma_f32_16x16x32_bf16 v[224:227], v[216:219], v[88:91], v[224:227]
    v_mfma_f32_16x16x32_bf16 v[212:215], v[164:167], a[140:143], v[212:215]
    s_waitcnt vmcnt(7)
    v_mfma_f32_16x16x32_bf16 v[224:227], v[216:219], v[92:95], v[224:227]
    s_waitcnt lgkmcnt(2)
    v_mfma_f32_16x16x32_bf16 v[192:195], v[144:147], a[144:147], v[192:195]
    ds_read_b128 v[156:159], v6 offset:5760
    s_waitcnt vmcnt(6)
    buffer_load_dwordx4 v[124:127], v20, s[64:67], s93 offen offset:0 sc1
    v_mfma_f32_16x16x32_bf16 v[196:199], v[144:147], a[148:151], v[196:199]
    ds_read_b128 v[160:163], v76
    s_waitcnt lgkmcnt(2)
    v_mfma_f32_16x16x32_bf16 v[224:227], v[216:219], v[96:99], v[224:227]
    v_mfma_f32_16x16x32_bf16 v[200:203], v[148:151], a[144:147], v[200:203]
    ds_read_b128 v[164:167], v6 offset:6144
    s_waitcnt vmcnt(6)
    buffer_load_dwordx4 v[128:131], v20, s[64:67], s90 offen offset:1024 sc1
    v_mfma_f32_16x16x32_bf16 v[204:207], v[148:151], a[148:151], v[204:207]
    v_mfma_f32_16x16x32_bf16 v[224:227], v[216:219], v[100:103], v[224:227]
    v_mfma_f32_16x16x32_bf16 v[208:211], v[152:155], a[144:147], v[208:211]
    s_waitcnt vmcnt(6)
    v_mfma_f32_16x16x32_bf16 v[224:227], v[216:219], v[104:107], v[224:227]
    v_mfma_f32_16x16x32_bf16 v[212:215], v[152:155], a[148:151], v[212:215]
    s_waitcnt vmcnt(5)
    v_mfma_f32_16x16x32_bf16 v[224:227], v[216:219], v[108:111], v[224:227]
    buffer_load_dwordx4 v[132:135], v20, s[64:67], s91 offen offset:1024 sc1
    s_waitcnt lgkmcnt(2)
    v_mfma_f32_16x16x32_bf16 v[192:195], v[156:159], a[152:155], v[192:195]
    v_xor_b32 v29, 256, v25
    v_add_u32 v29, 154112, v29
    v_mfma_f32_16x16x32_bf16 v[196:199], v[156:159], a[156:159], v[196:199]
    s_waitcnt lgkmcnt(0)
    v_add_u32 v28, 154112, v25
    v_mfma_f32_16x16x32_bf16 v[200:203], v[160:163], a[152:155], v[200:203]
    buffer_load_dwordx4 v[136:139], v20, s[64:67], s92 offen offset:1024 sc1
    v_mfma_f32_16x16x32_bf16 v[204:207], v[160:163], a[156:159], v[204:207]
    v_cmp_u_f32 vcc, v224, v225
    s_nop 0
    s_cbranch_vccnz L_slow_14
L_back_15:
    v_mfma_f32_16x16x32_bf16 v[208:211], v[164:167], a[152:155], v[208:211]
    v_cvt_pk_bf16_f32 v228, v224, v225
    v_cvt_pk_bf16_f32 v229, v226, v227
    v_mfma_f32_16x16x32_bf16 v[212:215], v[164:167], a[156:159], v[212:215]
    ds_write_b64 v222, v[228:229]
    buffer_load_dwordx4 v[140:143], v20, s[64:67], s93 offen offset:1024 sc1
    s_waitcnt lgkmcnt(0)
    s_barrier
    ds_read_b64 v[224:225], v28 offset:1024
    ds_read_b64 v[228:229], v29 offset:1536
    v_and_b32 v30, 12, v2
    v_add_u32 v30, v30, v2
    s_lshl_b32 s11, s3, 7
    s_add_u32 s11, s11, 151552
    v_lshl_add_u32 v30, v30, 2, s11
    v_fma_f32 v216, v200, s94, v10
    v_fma_f32 v217, v204, s94, v10
    v_exp_f32 v216, -v216
    v_exp_f32 v217, -v217
    buffer_load_dwordx4 v[144:147], v20, s[64:67], s90 offen offset:2048 sc1
    ds_read_b64 v[226:227], v28 offset:1536
    ds_read_b64 v[176:177], v28 offset:0
    v_add_f32 v216, 1.0, v216
    v_add_f32 v217, 1.0, v217
    v_rcp_f32 v216, v216
    v_rcp_f32 v217, v217
    v_sub_f32 v218, 1.0, v216
    v_sub_f32 v219, 1.0, v217
    buffer_load_dwordx4 v[148:151], v20, s[64:67], s91 offen offset:2048 sc1
    ds_read_b64 v[182:183], v28 offset:512
    s_mov_b32 exec_lo, 0
    ds_write_b32 v30, v216
    ds_write_b32 v30, v217 offset:16
    s_mov_b32 exec_lo, -1
    v_permlane32_swap_b32 v218, v252
    v_permlane32_swap_b32 v219, v253
    v_fma_f32 v232, v192, s94, v10
    v_fma_f32 v233, v193, s94, v10
    v_fma_f32 v234, v194, s94, v10
    v_fma_f32 v235, v195, s94, v10
    v_fma_f32 v236, v196, s94, v10
    v_fma_f32 v237, v197, s94, v10
    v_fma_f32 v238, v198, s94, v10
    v_fma_f32 v239, v199, s94, v10
    v_exp_f32 v232, v232 clamp
    v_max_f32 v192, s95, v192
    v_exp_f32 v233, v233 clamp
    v_max_f32 v193, s95, v193
    v_exp_f32 v234, v234 clamp
    buffer_load_dwordx4 v[152:155], v20, s[64:67], s92 offen offset:2048 sc1
    v_max_f32 v194, s95, v194
    v_exp_f32 v235, v235 clamp
    v_max_f32 v195, s95, v195
    v_exp_f32 v236, v236 clamp
    v_max_f32 v196, s95, v196
    v_exp_f32 v237, v237 clamp
    v_max_f32 v197, s95, v197
    v_exp_f32 v238, v238 clamp
    buffer_load_dwordx4 v[156:159], v20, s[64:67], s93 offen offset:2048 sc1
    v_max_f32 v198, s95, v198
    v_exp_f32 v239, v239 clamp
    v_max_f32 v199, s95, v199
    v_add_f32 v192, v192, v232
    v_add_f32 v193, v193, v233
    v_add_f32 v194, v194, v234
    v_add_f32 v195, v195, v235
    v_add_f32 v196, v196, v236
    v_add_f32 v197, v197, v237
    v_add_f32 v198, v198, v238
    s_waitcnt lgkmcnt(2)
    s_mov_b32 s98, 0xf550f55
    s_mov_b32 s99, 0xf550f55
    v_add_f32 v199, v199, v239
    v_cvt_pk_bf16_f32 v240, v192, v193
    v_cvt_pk_bf16_f32 v241, v194, v195
    v_cvt_pk_bf16_f32 v246, v196, v197
    v_cvt_pk_bf16_f32 v247, v198, v199
    v_fma_f32 v232, v200, s94, v10
    v_fma_f32 v233, v201, s94, v10
    v_fma_f32 v234, v202, s94, v10
    v_fma_f32 v235, v203, s94, v10
    v_fma_f32 v236, v204, s94, v10
    buffer_load_dwordx4 v[160:163], v20, s[64:67], s90 offen offset:3072 sc1
    v_cndmask_b32 v184, 0, v224, s[98:99]
    v_cndmask_b32 v185, 0, v225, s[98:99]
    v_fma_f32 v237, v205, s94, v10
    v_fma_f32 v238, v206, s94, v10
    v_fma_f32 v239, v207, s94, v10
    v_exp_f32 v232, v232 clamp
    v_max_f32 v200, s95, v200
    v_exp_f32 v233, v233 clamp
    v_max_f32 v201, s95, v201
    buffer_load_dwordx4 v[164:167], v20, s[64:67], s91 offen offset:3072 sc1
    s_mov_b32 s98, 0xf55
    s_mov_b32 s99, 0x0
    v_cndmask_b32 v186, 0, v228, s[98:99]
    v_exp_f32 v234, v234 clamp
    v_max_f32 v202, s95, v202
    v_exp_f32 v235, v235 clamp
    v_max_f32 v203, s95, v203
    v_exp_f32 v236, v236 clamp
    v_max_f32 v204, s95, v204
    buffer_load_dwordx4 v[168:171], v20, s[64:67], s92 offen offset:3072 sc1
    v_cndmask_b32 v187, 0, v229, s[98:99]
    s_mov_b32 s98, 0xf0aaf0aa
    s_mov_b32 s99, 0xf0aaf0aa
    v_exp_f32 v237, v237 clamp
    v_max_f32 v205, s95, v205
    v_exp_f32 v238, v238 clamp
    v_max_f32 v206, s95, v206
    v_exp_f32 v239, v239 clamp
    v_max_f32 v207, s95, v207
    buffer_load_dwordx4 v[172:175], v20, s[64:67], s93 offen offset:3072 sc1
    v_cndmask_b32 v190, 0, v224, s[98:99]
    v_cndmask_b32 v191, 0, v225, s[98:99]
    v_add_f32 v200, v200, v232
    v_add_f32 v201, v201, v233
    v_add_f32 v202, v202, v234
    v_add_f32 v203, v203, v235
    v_add_f32 v204, v204, v236
    v_add_f32 v205, v205, v237
    v_add_f32 v206, v206, v238
    v_add_f32 v207, v207, v239
    v_cvt_pk_bf16_f32 v242, v200, v201
    s_mov_b32 s98, 0xf0aa0000
    s_mov_b32 s99, 0x0
    v_cndmask_b32 v188, 0, v228, s[98:99]
    v_cvt_pk_bf16_f32 v243, v202, v203
    v_cvt_pk_bf16_f32 v248, v204, v205
    v_cvt_pk_bf16_f32 v249, v206, v207
    v_fma_f32 v232, v208, s94, v10
    v_fma_f32 v233, v209, s94, v10
    v_fma_f32 v234, v210, s94, v10
    v_fma_f32 v235, v211, s94, v10
    v_fma_f32 v236, v212, s94, v10
    v_fma_f32 v237, v213, s94, v10
    s_add_u32 s15, s28, 20480
    s_add_u32 m0, s9, 20480
    s_nop 0
    buffer_load_dwordx4 v20, s[64:67], s15 offen offset:0 sc1 lds
    v_cndmask_b32 v189, 0, v229, s[98:99]
    s_mov_b32 s98, 0xffff
    s_mov_b32 s99, 0x0
    v_fma_f32 v238, v214, s94, v10
    v_fma_f32 v239, v215, s94, v10
    v_exp_f32 v232, v232 clamp
    v_max_f32 v208, s95, v208
    v_exp_f32 v233, v233 clamp
    v_max_f32 v209, s95, v209
    v_exp_f32 v234, v234 clamp
    buffer_load_dwordx4 v20, s[64:67], s15 offen offset:1024 sc1 lds
    v_cndmask_b32 v178, 0, v226, s[98:99]
    v_cndmask_b32 v179, 0, v227, s[98:99]
    v_max_f32 v210, s95, v210
    v_exp_f32 v235, v235 clamp
    v_max_f32 v211, s95, v211
    v_exp_f32 v236, v236 clamp
    v_max_f32 v212, s95, v212
    v_exp_f32 v237, v237 clamp
    buffer_load_dwordx4 v20, s[64:67], s15 offen offset:2048 sc1 lds
    s_mov_b32 s98, 0xffff0000
    s_mov_b32 s99, 0x0
    v_cndmask_b32 v180, 0, v226, s[98:99]
    v_max_f32 v213, s95, v213
    v_exp_f32 v238, v238 clamp
    v_max_f32 v214, s95, v214
    v_exp_f32 v239, v239 clamp
    v_max_f32 v215, s95, v215
    v_add_f32 v208, v208, v232
    v_add_f32 v209, v209, v233
    buffer_load_dwordx4 v20, s[64:67], s15 offen offset:3072 sc1 lds
    v_cndmask_b32 v181, 0, v227, s[98:99]
    v_add_f32 v210, v210, v234
    v_add_f32 v211, v211, v235
    v_add_f32 v212, v212, v236
    v_add_f32 v213, v213, v237
    v_add_f32 v214, v214, v238
    v_add_f32 v215, v215, v239
    v_cvt_pk_bf16_f32 v244, v208, v209
    v_cvt_pk_bf16_f32 v245, v210, v211
    v_cvt_pk_bf16_f32 v250, v212, v213
    v_cvt_pk_bf16_f32 v251, v214, v215
    s_add_u32 m0, s9, 24576
    s_nop 0
    buffer_load_dwordx4 v22, s[64:67], s15 offen sc1 lds
    s_waitcnt vmcnt(17)
    v_mfma_f32_16x16x32_bf16 v[32:35], v[112:115], a[160:163], v[32:35]
    v_mfma_f32_16x16x32_bf16 v[200:203], v[184:187], v[240:243], 0
    v_mfma_f32_16x16x32_bf16 v[212:215], v[184:187], v[246:249], 0
    v_mfma_f32_16x16x32_bf16 v[200:203], v[188:191], v[242:245], v[200:203]
    v_mfma_f32_16x16x32_bf16 v[36:39], v[112:115], a[168:171], v[36:39]
    v_mfma_f32_16x16x32_bf16 v[212:215], v[188:191], v[248:251], v[212:215]
    v_lshrrev_b32 v30, 1, v3
    v_mul_u32_u24 v30, 61440, v30
    v_and_b32 v31, 1, v3
    v_lshl_add_u32 v30, v31, 3, v30
    s_add_u32 s15, s28, 40960
    s_add_u32 m0, s9, 61440
    s_nop 0
    buffer_load_dwordx4 v20, s[64:67], s15 offen offset:0 sc1 lds
    v_mfma_f32_16x16x32_bf16 v[40:43], v[112:115], a[176:179], v[40:43]
    v_lshl_add_u32 v30, v2, 4, v30
    s_add_u32 s12, s96, 40960
    s_add_u32 s13, s96, 102400
    v_mfma_f32_16x16x32_bf16 v[192:195], v[176:179], v[240:243], 0
    v_mfma_f32_16x16x32_bf16 v[196:199], v[180:183], v[242:245], 0
    buffer_load_dwordx4 v20, s[64:67], s15 offen offset:1024 sc1 lds
    v_mfma_f32_16x16x32_bf16 v[44:47], v[112:115], a[184:187], v[44:47]
    v_mfma_f32_16x16x32_bf16 v[204:207], v[176:179], v[246:249], 0
    v_mfma_f32_16x16x32_bf16 v[208:211], v[180:183], v[248:251], 0
    s_mov_b32 s98, 0
    s_mov_b32 s99, 0x0000ffff
    v_mfma_f32_16x16x32_bf16 v[48:51], v[112:115], a[192:195], v[48:51]
    v_add_f32 v216, s95, v200
    v_add_f32 v218, s95, v201
    v_add_f32 v222, s95, v212
    v_add_f32 v224, s95, v213
    v_rcp_f32 v216, v216
    buffer_load_dwordx4 v20, s[64:67], s15 offen offset:2048 sc1 lds
    v_mfma_f32_16x16x32_bf16 v[52:55], v[116:119], a[160:163], 0
    v_rcp_f32 v218, v218
    v_rcp_f32 v222, v222
    v_rcp_f32 v224, v224
    v_mfma_f32_16x16x32_bf16 v[56:59], v[116:119], a[168:171], 0
    v_mul_f32 v216, v216, v252
    v_mul_f32 v218, v218, v252
    v_mul_f32 v222, v222, v253
    v_mul_f32 v224, v224, v253
    v_mov_b32 v217, v216
    v_mov_b32 v219, v218
    buffer_load_dwordx4 v20, s[64:67], s15 offen offset:3072 sc1 lds
    v_mfma_f32_16x16x32_bf16 v[60:63], v[116:119], a[176:179], 0
    v_mov_b32 v223, v222
    v_mov_b32 v225, v224
    v_permlane32_swap_b32 v216, v217
    v_permlane32_swap_b32 v218, v219
    v_permlane32_swap_b32 v222, v223
    v_permlane32_swap_b32 v224, v225
    v_mfma_f32_16x16x32_bf16 v[64:67], v[116:119], a[184:187], 0
    v_cndmask_b32 v220, v218, v216, s[98:99]
    v_mul_f32 v192, v192, v216
    v_mul_f32 v196, v196, v218
    v_mul_f32 v193, v193, v216
    v_mul_f32 v197, v197, v218
    v_mul_f32 v194, v194, v216
    s_add_u32 m0, s9, 65536
    s_nop 0
    buffer_load_dwordx4 v22, s[64:67], s15 offen sc1 lds
    v_mfma_f32_16x16x32_bf16 v[68:71], v[116:119], a[192:195], 0
    v_mul_f32 v198, v198, v218
    v_mul_f32 v195, v195, v216
    v_mul_f32 v199, v199, v218
    v_cvt_pk_bf16_f32 v176, v192, v193
    v_cvt_pk_bf16_f32 v177, v194, v195
    v_cvt_pk_bf16_f32 v178, v196, v197
    v_mfma_f32_16x16x32_bf16 v[72:75], v[120:123], a[160:163], 0
    v_cvt_pk_bf16_f32 v179, v198, v199
    buffer_store_dwordx4 v[176:179], v20, s[64:67], s12 offen sc1
    v_cndmask_b32 v226, v224, v222, s[98:99]
    v_mfma_f32_16x16x32_bf16 v[76:79], v[120:123], a[168:171], 0
    v_mul_f32 v204, v204, v222
    v_mul_f32 v208, v208, v224
    v_mul_f32 v205, v205, v222
    v_mul_f32 v209, v209, v224
    v_mul_f32 v206, v206, v222
    v_mul_f32 v210, v210, v224
    v_mfma_f32_16x16x32_bf16 v[80:83], v[120:123], a[176:179], 0
    v_mul_f32 v207, v207, v222
    v_mul_f32 v211, v211, v224
    v_cvt_pk_bf16_f32 v180, v204, v205
    v_cvt_pk_bf16_f32 v181, v206, v207
    v_cvt_pk_bf16_f32 v182, v208, v209
    v_cvt_pk_bf16_f32 v183, v210, v211
    v_mfma_f32_16x16x32_bf16 v[84:87], v[120:123], a[184:187], 0
    buffer_store_dwordx4 v[180:183], v20, s[64:67], s13 offen sc1
    v_mul_f32 v200, v200, v220
    v_mul_f32 v201, v201, v220
    v_mfma_f32_16x16x32_bf16 v[88:91], v[120:123], a[192:195], 0
    v_mul_f32 v202, v202, v220
    v_mul_f32 v203, v203, v220
    v_cvt_pk_bf16_f32 v184, v200, v201
    v_cvt_pk_bf16_f32 v185, v202, v203
    v_mul_f32 v212, v212, v226
    v_mul_f32 v213, v213, v226
    v_mfma_f32_16x16x32_bf16 v[92:95], v[124:127], a[160:163], 0
    v_mul_f32 v214, v214, v226
    v_mul_f32 v215, v215, v226
    v_cvt_pk_bf16_f32 v186, v212, v213
    v_cvt_pk_bf16_f32 v187, v214, v215
    s_nop 0
    v_permlane32_swap_b32 v184, v186
    v_permlane32_swap_b32 v185, v187
    v_mfma_f32_16x16x32_bf16 v[96:99], v[124:127], a[168:171], 0
    buffer_store_dwordx2 v[186:187], v30, s[64:67], s12 offen offset:1024 sc1
    v_mfma_f32_16x16x32_bf16 v[100:103], v[124:127], a[176:179], 0
    v_mfma_f32_16x16x32_bf16 v[104:107], v[124:127], a[184:187], 0
    v_mfma_f32_16x16x32_bf16 v[108:111], v[124:127], a[192:195], 0
    s_waitcnt vmcnt(21)
    v_mfma_f32_16x16x32_bf16 v[32:35], v[128:131], a[164:167], v[32:35]
    v_mfma_f32_16x16x32_bf16 v[36:39], v[128:131], a[172:175], v[36:39]
    v_mfma_f32_16x16x32_bf16 v[40:43], v[128:131], a[180:183], v[40:43]
    v_mfma_f32_16x16x32_bf16 v[44:47], v[128:131], a[188:191], v[44:47]
    v_mfma_f32_16x16x32_bf16 v[48:51], v[128:131], a[196:199], v[48:51]
    v_mfma_f32_16x16x32_bf16 v[52:55], v[132:135], a[164:167], v[52:55]
    v_mfma_f32_16x16x32_bf16 v[56:59], v[132:135], a[172:175], v[56:59]
    v_mfma_f32_16x16x32_bf16 v[60:63], v[132:135], a[180:183], v[60:63]
    v_mfma_f32_16x16x32_bf16 v[64:67], v[132:135], a[188:191], v[64:67]
    v_mfma_f32_16x16x32_bf16 v[68:71], v[132:135], a[196:199], v[68:71]
    v_mfma_f32_16x16x32_bf16 v[72:75], v[136:139], a[164:167], v[72:75]
    v_mfma_f32_16x16x32_bf16 v[76:79], v[136:139], a[172:175], v[76:79]
    v_mfma_f32_16x16x32_bf16 v[80:83], v[136:139], a[180:183], v[80:83]
    v_mfma_f32_16x16x32_bf16 v[84:87], v[136:139], a[188:191], v[84:87]
    v_mfma_f32_16x16x32_bf16 v[88:91], v[136:139], a[196:199], v[88:91]
    v_mfma_f32_16x16x32_bf16 v[92:95], v[140:143], a[164:167], v[92:95]
    v_mfma_f32_16x16x32_bf16 v[96:99], v[140:143], a[172:175], v[96:99]
    v_mfma_f32_16x16x32_bf16 v[100:103], v[140:143], a[180:183], v[100:103]
    v_mfma_f32_16x16x32_bf16 v[104:107], v[140:143], a[188:191], v[104:107]
    v_mfma_f32_16x16x32_bf16 v[108:111], v[140:143], a[196:199], v[108:111]
    buffer_load_dwordx4 v[112:115], v22, s[64:67], s90 offen offset:0 sc1
    s_waitcnt vmcnt(18)
    v_mfma_f32_16x16x32_bf16 v[32:35], v[144:147], a[200:203], v[32:35]
    v_mfma_f32_16x16x32_bf16 v[36:39], v[144:147], a[208:211], v[36:39]
    v_mfma_f32_16x16x32_bf16 v[40:43], v[144:147], a[216:219], v[40:43]
    v_mfma_f32_16x16x32_bf16 v[44:47], v[144:147], a[224:227], v[44:47]
    buffer_load_dwordx4 v[116:119], v22, s[64:67], s91 offen offset:0 sc1
    v_mfma_f32_16x16x32_bf16 v[48:51], v[144:147], a[232:235], v[48:51]
    v_mfma_f32_16x16x32_bf16 v[52:55], v[148:151], a[200:203], v[52:55]
    v_mfma_f32_16x16x32_bf16 v[56:59], v[148:151], a[208:211], v[56:59]
    v_mfma_f32_16x16x32_bf16 v[60:63], v[148:151], a[216:219], v[60:63]
    buffer_load_dwordx4 v[120:123], v22, s[64:67], s92 offen offset:0 sc1
    v_mfma_f32_16x16x32_bf16 v[64:67], v[148:151], a[224:227], v[64:67]
    v_mfma_f32_16x16x32_bf16 v[68:71], v[148:151], a[232:235], v[68:71]
    v_mfma_f32_16x16x32_bf16 v[72:75], v[152:155], a[200:203], v[72:75]
    v_mfma_f32_16x16x32_bf16 v[76:79], v[152:155], a[208:211], v[76:79]
    buffer_load_dwordx4 v[124:127], v22, s[64:67], s93 offen offset:0 sc1
    v_mfma_f32_16x16x32_bf16 v[80:83], v[152:155], a[216:219], v[80:83]
    v_mfma_f32_16x16x32_bf16 v[84:87], v[152:155], a[224:227], v[84:87]
    v_mfma_f32_16x16x32_bf16 v[88:91], v[152:155], a[232:235], v[88:91]
    v_mfma_f32_16x16x32_bf16 v[92:95], v[156:159], a[200:203], v[92:95]
    buffer_load_dwordx4 v[128:131], v22, s[64:67], s90 offen offset:1024 sc1
    v_mfma_f32_16x16x32_bf16 v[96:99], v[156:159], a[208:211], v[96:99]
    v_mfma_f32_16x16x32_bf16 v[100:103], v[156:159], a[216:219], v[100:103]
    v_mfma_f32_16x16x32_bf16 v[104:107], v[156:159], a[224:227], v[104:107]
    v_mfma_f32_16x16x32_bf16 v[108:111], v[156:159], a[232:235], v[108:111]
    buffer_load_dwordx4 v[132:135], v22, s[64:67], s91 offen offset:1024 sc1
    s_waitcnt vmcnt(19)
    v_mfma_f32_16x16x32_bf16 v[32:35], v[160:163], a[204:207], v[32:35]
    s_waitcnt vmcnt(6)
    s_mov_b64 exec, 1
    buffer_atomic_add v27, off, s[64:67], s41 sc1
    s_mov_b64 exec, -1
    v_mfma_f32_16x16x32_bf16 v[36:39], v[160:163], a[212:215], v[36:39]
    v_mfma_f32_16x16x32_bf16 v[40:43], v[160:163], a[220:223], v[40:43]
    v_mfma_f32_16x16x32_bf16 v[44:47], v[160:163], a[228:231], v[44:47]
    v_mfma_f32_16x16x32_bf16 v[48:51], v[160:163], a[236:239], v[48:51]
    v_mfma_f32_16x16x32_bf16 v[52:55], v[164:167], a[204:207], v[52:55]
    v_mfma_f32_16x16x32_bf16 v[56:59], v[164:167], a[212:215], v[56:59]
    buffer_load_dwordx4 v[136:139], v22, s[64:67], s92 offen offset:1024 sc1
    v_mfma_f32_16x16x32_bf16 v[60:63], v[164:167], a[220:223], v[60:63]
    v_mfma_f32_16x16x32_bf16 v[64:67], v[164:167], a[228:231], v[64:67]
    v_mfma_f32_16x16x32_bf16 v[68:71], v[164:167], a[236:239], v[68:71]
    v_mfma_f32_16x16x32_bf16 v[72:75], v[168:171], a[204:207], v[72:75]
    buffer_load_dwordx4 v[140:143], v22, s[64:67], s93 offen offset:1024 sc1
    v_mfma_f32_16x16x32_bf16 v[76:79], v[168:171], a[212:215], v[76:79]
    v_mfma_f32_16x16x32_bf16 v[80:83], v[168:171], a[220:223], v[80:83]
    v_mfma_f32_16x16x32_bf16 v[84:87], v[168:171], a[228:231], v[84:87]
    v_mfma_f32_16x16x32_bf16 v[88:91], v[168:171], a[236:239], v[88:91]
    buffer_load_dwordx4 v[144:147], v22, s[64:67], s90 offen offset:2048 sc1
    v_mfma_f32_16x16x32_bf16 v[92:95], v[172:175], a[204:207], v[92:95]
    v_mfma_f32_16x16x32_bf16 v[96:99], v[172:175], a[212:215], v[96:99]
    v_mfma_f32_16x16x32_bf16 v[100:103], v[172:175], a[220:223], v[100:103]
    v_mfma_f32_16x16x32_bf16 v[104:107], v[172:175], a[228:231], v[104:107]
    buffer_load_dwordx4 v[148:151], v22, s[64:67], s91 offen offset:2048 sc1
    v_mfma_f32_16x16x32_bf16 v[108:111], v[172:175], a[236:239], v[108:111]
    s_waitcnt vmcnt(7)
    v_mfma_f32_16x16x32_bf16 v[32:35], v[112:115], a[240:243], v[32:35]
    v_mfma_f32_16x16x32_bf16 v[36:39], v[112:115], a[248:251], v[36:39]
    v_mfma_f32_16x16x32_bf16 v[40:43], v[112:115], a[0:3], v[40:43]
    buffer_load_dwordx4 v[152:155], v22, s[64:67], s92 offen offset:2048 sc1
    v_mfma_f32_16x16x32_bf16 v[44:47], v[112:115], a[8:11], v[44:47]
    v_mfma_f32_16x16x32_bf16 v[48:51], v[112:115], a[16:19], v[48:51]
    v_mfma_f32_16x16x32_bf16 v[52:55], v[116:119], a[240:243], v[52:55]
    v_mfma_f32_16x16x32_bf16 v[56:59], v[116:119], a[248:251], v[56:59]
    buffer_load_dwordx4 v[156:159], v22, s[64:67], s93 offen offset:2048 sc1
    v_mfma_f32_16x16x32_bf16 v[60:63], v[116:119], a[0:3], v[60:63]
    v_mfma_f32_16x16x32_bf16 v[64:67], v[116:119], a[8:11], v[64:67]
    v_mfma_f32_16x16x32_bf16 v[68:71], v[116:119], a[16:19], v[68:71]
    v_mfma_f32_16x16x32_bf16 v[72:75], v[120:123], a[240:243], v[72:75]
    buffer_load_dwordx4 v[160:163], v22, s[64:67], s90 offen offset:3072 sc1
    v_mfma_f32_16x16x32_bf16 v[76:79], v[120:123], a[248:251], v[76:79]
    v_mfma_f32_16x16x32_bf16 v[80:83], v[120:123], a[0:3], v[80:83]
    v_mfma_f32_16x16x32_bf16 v[84:87], v[120:123], a[8:11], v[84:87]
    v_mfma_f32_16x16x32_bf16 v[88:91], v[120:123], a[16:19], v[88:91]
    buffer_load_dwordx4 v[164:167], v22, s[64:67], s91 offen offset:3072 sc1
    v_mfma_f32_16x16x32_bf16 v[92:95], v[124:127], a[240:243], v[92:95]
    v_mfma_f32_16x16x32_bf16 v[96:99], v[124:127], a[248:251], v[96:99]
    v_mfma_f32_16x16x32_bf16 v[100:103], v[124:127], a[0:3], v[100:103]
    v_mfma_f32_16x16x32_bf16 v[104:107], v[124:127], a[8:11], v[104:107]
    buffer_load_dwordx4 v[168:171], v22, s[64:67], s92 offen offset:3072 sc1
    v_mfma_f32_16x16x32_bf16 v[108:111], v[124:127], a[16:19], v[108:111]
    s_waitcnt vmcnt(7)
    v_mfma_f32_16x16x32_bf16 v[32:35], v[128:131], a[244:247], v[32:35]
    v_mfma_f32_16x16x32_bf16 v[36:39], v[128:131], a[252:255], v[36:39]
    v_mfma_f32_16x16x32_bf16 v[40:43], v[128:131], a[4:7], v[40:43]
    buffer_load_dwordx4 v[172:175], v22, s[64:67], s93 offen offset:3072 sc1
    v_mfma_f32_16x16x32_bf16 v[44:47], v[128:131], a[12:15], v[44:47]
    v_mfma_f32_16x16x32_bf16 v[48:51], v[128:131], a[20:23], v[48:51]
    v_mfma_f32_16x16x32_bf16 v[52:55], v[132:135], a[244:247], v[52:55]
    v_mfma_f32_16x16x32_bf16 v[56:59], v[132:135], a[252:255], v[56:59]
    buffer_load_dword v26, off, s[64:67], s45 offset:0 sc1
    v_mfma_f32_16x16x32_bf16 v[60:63], v[132:135], a[4:7], v[60:63]
    v_mfma_f32_16x16x32_bf16 v[64:67], v[132:135], a[12:15], v[64:67]
    buffer_load_dwordx4 v[112:115], v23, s[64:67], s90 offen offset:0 sc1
    v_mfma_f32_16x16x32_bf16 v[68:71], v[132:135], a[20:23], v[68:71]
    v_mfma_f32_16x16x32_bf16 v[72:75], v[136:139], a[244:247], v[72:75]
    v_mfma_f32_16x16x32_bf16 v[76:79], v[136:139], a[252:255], v[76:79]
    v_mfma_f32_16x16x32_bf16 v[80:83], v[136:139], a[4:7], v[80:83]
    buffer_load_dwordx4 v[116:119], v23, s[64:67], s91 offen offset:0 sc1
    v_mfma_f32_16x16x32_bf16 v[84:87], v[136:139], a[12:15], v[84:87]
    v_mfma_f32_16x16x32_bf16 v[88:91], v[136:139], a[20:23], v[88:91]
    v_mfma_f32_16x16x32_bf16 v[92:95], v[140:143], a[244:247], v[92:95]
    v_mfma_f32_16x16x32_bf16 v[96:99], v[140:143], a[252:255], v[96:99]
    buffer_load_dwordx4 v[120:123], v23, s[64:67], s92 offen offset:0 sc1
    v_mfma_f32_16x16x32_bf16 v[100:103], v[140:143], a[4:7], v[100:103]
    v_mfma_f32_16x16x32_bf16 v[104:107], v[140:143], a[12:15], v[104:107]
    v_mfma_f32_16x16x32_bf16 v[108:111], v[140:143], a[20:23], v[108:111]
    s_waitcnt vmcnt(8)
    v_mfma_f32_16x16x32_bf16 v[32:35], v[144:147], a[24:27], v[32:35]
    v_add_u32 v9, 94208, v6
    ds_read_b128 a[184:187], v9 offset:0
    buffer_load_dwordx4 v[124:127], v23, s[64:67], s93 offen offset:0 sc1
    v_mfma_f32_16x16x32_bf16 v[36:39], v[144:147], a[32:35], v[36:39]
    v_mfma_f32_16x16x32_bf16 v[40:43], v[144:147], a[40:43], v[40:43]
    ds_read_b128 a[188:191], v9 offset:256
    v_mfma_f32_16x16x32_bf16 v[44:47], v[144:147], a[48:51], v[44:47]
    buffer_load_dwordx4 v[128:131], v23, s[64:67], s90 offen offset:1024 sc1
    v_mfma_f32_16x16x32_bf16 v[48:51], v[144:147], a[56:59], v[48:51]
    ds_read_b128 a[192:195], v9 offset:512
    v_mfma_f32_16x16x32_bf16 v[52:55], v[148:151], a[24:27], v[52:55]
    v_mfma_f32_16x16x32_bf16 v[56:59], v[148:151], a[32:35], v[56:59]
    ds_read_b128 a[196:199], v9 offset:768
    v_mfma_f32_16x16x32_bf16 v[60:63], v[148:151], a[40:43], v[60:63]
    buffer_load_dwordx4 v[132:135], v23, s[64:67], s91 offen offset:1024 sc1
    v_mfma_f32_16x16x32_bf16 v[64:67], v[148:151], a[48:51], v[64:67]
    ds_read_b128 a[200:203], v9 offset:1024
    v_mfma_f32_16x16x32_bf16 v[68:71], v[148:151], a[56:59], v[68:71]
    v_mfma_f32_16x16x32_bf16 v[72:75], v[152:155], a[24:27], v[72:75]
    ds_read_b128 a[204:207], v9 offset:17408
    v_mfma_f32_16x16x32_bf16 v[76:79], v[152:155], a[32:35], v[76:79]
    buffer_load_dwordx4 v[136:139], v23, s[64:67], s92 offen offset:1024 sc1
    v_mfma_f32_16x16x32_bf16 v[80:83], v[152:155], a[40:43], v[80:83]
    ds_read_b128 a[208:211], v9 offset:17664
    v_mfma_f32_16x16x32_bf16 v[84:87], v[152:155], a[48:51], v[84:87]
    v_mfma_f32_16x16x32_bf16 v[88:91], v[152:155], a[56:59], v[88:91]
    ds_read_b128 a[212:215], v9 offset:17920
    v_mfma_f32_16x16x32_bf16 v[92:95], v[156:159], a[24:27], v[92:95]
    buffer_load_dwordx4 v[140:143], v23, s[64:67], s93 offen offset:1024 sc1
    v_mfma_f32_16x16x32_bf16 v[96:99], v[156:159], a[32:35], v[96:99]
    ds_read_b128 a[216:219], v9 offset:18176
    v_mfma_f32_16x16x32_bf16 v[100:103], v[156:159], a[40:43], v[100:103]
    v_mfma_f32_16x16x32_bf16 v[104:107], v[156:159], a[48:51], v[104:107]
    ds_read_b128 a[220:223], v9 offset:18432
    v_mfma_f32_16x16x32_bf16 v[108:111], v[156:159], a[56:59], v[108:111]
    s_add_u32 s15, s28, 61440
    s_add_u32 m0, s9, 0
    s_nop 0
    buffer_load_dwordx4 v20, s[64:67], s15 offen offset:0 sc1 lds
    s_waitcnt vmcnt(10)
    v_mfma_f32_16x16x32_bf16 v[32:35], v[160:163], a[28:31], v[32:35]
    ds_read_b128 a[224:227], v9 offset:34816
    v_mfma_f32_16x16x32_bf16 v[36:39], v[160:163], a[36:39], v[36:39]
    v_mfma_f32_16x16x32_bf16 v[40:43], v[160:163], a[44:47], v[40:43]
    ds_read_b128 a[228:231], v9 offset:35072
    buffer_load_dwordx4 v20, s[64:67], s15 offen offset:1024 sc1 lds
    v_mfma_f32_16x16x32_bf16 v[44:47], v[160:163], a[52:55], v[44:47]
    v_mfma_f32_16x16x32_bf16 v[48:51], v[160:163], a[60:63], v[48:51]
    ds_read_b128 a[232:235], v9 offset:35328
    v_mfma_f32_16x16x32_bf16 v[52:55], v[164:167], a[28:31], v[52:55]
    v_mfma_f32_16x16x32_bf16 v[56:59], v[164:167], a[36:39], v[56:59]
    ds_read_b128 a[236:239], v9 offset:35584
    buffer_load_dwordx4 v20, s[64:67], s15 offen offset:2048 sc1 lds
    v_mfma_f32_16x16x32_bf16 v[60:63], v[164:167], a[44:47], v[60:63]
    v_mfma_f32_16x16x32_bf16 v[64:67], v[164:167], a[52:55], v[64:67]
    ds_read_b128 a[240:243], v9 offset:35840
    v_mfma_f32_16x16x32_bf16 v[68:71], v[164:167], a[60:63], v[68:71]
    buffer_load_dwordx4 v20, s[64:67], s15 offen offset:3072 sc1 lds
    v_mfma_f32_16x16x32_bf16 v[72:75], v[168:171], a[28:31], v[72:75]
    ds_read_b128 a[244:247], v9 offset:52224
    v_mfma_f32_16x16x32_bf16 v[76:79], v[168:171], a[36:39], v[76:79]
    v_mfma_f32_16x16x32_bf16 v[80:83], v[168:171], a[44:47], v[80:83]
    ds_read_b128 a[248:251], v9 offset:52480
    v_mfma_f32_16x16x32_bf16 v[84:87], v[168:171], a[52:55], v[84:87]
    s_add_u32 m0, s9, 4096
    s_nop 0
    buffer_load_dwordx4 v22, s[64:67], s15 offen sc1 lds
    v_mfma_f32_16x16x32_bf16 v[88:91], v[168:171], a[60:63], v[88:91]
    ds_read_b128 a[252:255], v9 offset:52736
    v_mfma_f32_16x16x32_bf16 v[92:95], v[172:175], a[28:31], v[92:95]
    v_mfma_f32_16x16x32_bf16 v[96:99], v[172:175], a[36:39], v[96:99]
    ds_read_b128 a[0:3], v9 offset:52992
    v_mfma_f32_16x16x32_bf16 v[100:103], v[172:175], a[44:47], v[100:103]
    v_mfma_f32_16x16x32_bf16 v[104:107], v[172:175], a[52:55], v[104:107]
    ds_read_b128 a[4:7], v9 offset:53248
    s_waitcnt vmcnt(13)
    v_readfirstlane_b32 s29, v26
    s_nop 0
    s_cmp_ge_u32 s29, 16
    s_cbranch_scc0 L_slow_18
L_back_19:
    buffer_load_dwordx4 a[168:171], v20, s[64:67], s23 offen offset:0 sc1
    v_mfma_f32_16x16x32_bf16 v[108:111], v[172:175], a[60:63], v[108:111]
    s_waitcnt lgkmcnt(0)
    s_barrier
    s_waitcnt vmcnt(10)
    v_mfma_f32_16x16x32_bf16 v[52:55], v[116:119], a[64:67], v[52:55]
    buffer_load_dwordx4 a[172:175], v20, s[64:67], s23 offen offset:1024 sc1
    v_mfma_f32_16x16x32_bf16 v[56:59], v[116:119], a[72:75], v[56:59]
    v_mfma_f32_16x16x32_bf16 v[60:63], v[116:119], a[80:83], v[60:63]
    v_mfma_f32_16x16x32_bf16 v[64:67], v[116:119], a[88:91], v[64:67]
    v_mfma_f32_16x16x32_bf16 v[68:71], v[116:119], a[96:99], v[68:71]
    s_waitcnt vmcnt(7)
    buffer_load_dwordx4 a[176:179], v20, s[64:67], s23 offen offset:2048 sc1
    v_mfma_f32_16x16x32_bf16 v[52:55], v[132:135], a[68:71], v[52:55]
    v_mfma_f32_16x16x32_bf16 v[56:59], v[132:135], a[76:79], v[56:59]
    v_mfma_f32_16x16x32_bf16 v[60:63], v[132:135], a[84:87], v[60:63]
    buffer_load_dwordx4 a[180:183], v20, s[64:67], s23 offen offset:3072 sc1
    v_mfma_f32_16x16x32_bf16 v[64:67], v[132:135], a[92:95], v[64:67]
    v_mfma_f32_16x16x32_bf16 v[68:71], v[132:135], a[100:103], v[68:71]
    v_mfma_f32_16x16x32_bf16 v[72:75], v[120:123], a[64:67], v[72:75]
    s_nop 1
    ds_write_b128 v15, v[52:55] offset:0
    v_mfma_f32_16x16x32_bf16 v[76:79], v[120:123], a[72:75], v[76:79]
    buffer_load_dwordx4 a[104:107], v20, s[64:67], s22 offen offset:0 sc1
    v_mfma_f32_16x16x32_bf16 v[80:83], v[120:123], a[80:83], v[80:83]
    ds_write_b128 v15, v[56:59] offset:1024
    v_mfma_f32_16x16x32_bf16 v[84:87], v[120:123], a[88:91], v[84:87]
    buffer_load_dwordx4 a[108:111], v20, s[64:67], s22 offen offset:1024 sc1
    v_mfma_f32_16x16x32_bf16 v[88:91], v[120:123], a[96:99], v[88:91]
    ds_write_b128 v15, v[60:63] offset:2048
    v_mfma_f32_16x16x32_bf16 v[72:75], v[136:139], a[68:71], v[72:75]
    buffer_load_dwordx4 a[112:115], v20, s[64:67], s22 offen offset:2048 sc1
    v_mfma_f32_16x16x32_bf16 v[76:79], v[136:139], a[76:79], v[76:79]
    ds_write_b128 v15, v[64:67] offset:3072
    v_mfma_f32_16x16x32_bf16 v[80:83], v[136:139], a[84:87], v[80:83]
    buffer_load_dwordx4 a[116:119], v20, s[64:67], s22 offen offset:3072 sc1
    v_mfma_f32_16x16x32_bf16 v[84:87], v[136:139], a[92:95], v[84:87]
    ds_write_b128 v15, v[68:71] offset:4096
    v_mfma_f32_16x16x32_bf16 v[88:91], v[136:139], a[100:103], v[88:91]
    buffer_load_dwordx4 a[120:123], v22, s[64:67], s22 offen offset:0 sc1
    v_mfma_f32_16x16x32_bf16 v[92:95], v[124:127], a[64:67], v[92:95]
    ds_write_b128 v15, v[72:75] offset:5120
    v_mfma_f32_16x16x32_bf16 v[96:99], v[124:127], a[72:75], v[96:99]
    buffer_load_dwordx4 a[124:127], v22, s[64:67], s22 offen offset:1024 sc1
    v_mfma_f32_16x16x32_bf16 v[100:103], v[124:127], a[80:83], v[100:103]
    v_lshl_add_u32 v21, v3, 5, s86
    ds_read_b128 v[176:179], v21
    ds_write_b128 v15, v[76:79] offset:6144
    v_mfma_f32_16x16x32_bf16 v[104:107], v[124:127], a[88:91], v[104:107]
    buffer_load_dwordx4 a[128:131], v22, s[64:67], s22 offen offset:2048 sc1
    v_mfma_f32_16x16x32_bf16 v[108:111], v[124:127], a[96:99], v[108:111]
    ds_write_b128 v15, v[80:83] offset:7168
    v_mfma_f32_16x16x32_bf16 v[92:95], v[140:143], a[68:71], v[92:95]
    buffer_load_dwordx4 a[132:135], v22, s[64:67], s22 offen offset:3072 sc1
    v_mfma_f32_16x16x32_bf16 v[96:99], v[140:143], a[76:79], v[96:99]
    ds_write_b128 v15, v[84:87] offset:8192
    v_mfma_f32_16x16x32_bf16 v[100:103], v[140:143], a[84:87], v[100:103]
    buffer_load_dwordx4 a[136:139], v23, s[64:67], s22 offen offset:0 sc1
    v_mfma_f32_16x16x32_bf16 v[104:107], v[140:143], a[92:95], v[104:107]
    ds_write_b128 v15, v[88:91] offset:9216
    v_mfma_f32_16x16x32_bf16 v[108:111], v[140:143], a[100:103], v[108:111]
    buffer_load_dwordx4 a[140:143], v23, s[64:67], s22 offen offset:1024 sc1
    v_mfma_f32_16x16x32_bf16 v[32:35], v[112:115], a[64:67], v[32:35]
    ds_write_b128 v15, v[92:95] offset:10240
    v_mfma_f32_16x16x32_bf16 v[36:39], v[112:115], a[72:75], v[36:39]
    buffer_load_dwordx4 a[144:147], v23, s[64:67], s22 offen offset:2048 sc1
    v_mfma_f32_16x16x32_bf16 v[40:43], v[112:115], a[80:83], v[40:43]
    ds_write_b128 v15, v[96:99] offset:11264
    v_mfma_f32_16x16x32_bf16 v[44:47], v[112:115], a[88:91], v[44:47]
    buffer_load_dwordx4 a[148:151], v23, s[64:67], s22 offen offset:3072 sc1
    v_mfma_f32_16x16x32_bf16 v[48:51], v[112:115], a[96:99], v[48:51]
    ds_write_b128 v15, v[100:103] offset:12288
    v_mfma_f32_16x16x32_bf16 v[32:35], v[128:131], a[68:71], v[32:35]
    buffer_load_dwordx4 a[152:155], v24, s[64:67], s22 offen offset:0 sc1
    v_mfma_f32_16x16x32_bf16 v[36:39], v[128:131], a[76:79], v[36:39]
    ds_write_b128 v15, v[104:107] offset:13312
    v_mfma_f32_16x16x32_bf16 v[40:43], v[128:131], a[84:87], v[40:43]
    buffer_load_dwordx4 a[156:159], v24, s[64:67], s22 offen offset:1024 sc1
    v_mfma_f32_16x16x32_bf16 v[44:47], v[128:131], a[92:95], v[44:47]
    ds_write_b128 v15, v[108:111] offset:14336
    v_mfma_f32_16x16x32_bf16 v[48:51], v[128:131], a[100:103], v[48:51]
    buffer_load_dwordx4 a[160:163], v24, s[64:67], s22 offen offset:2048 sc1
    s_waitcnt lgkmcnt(0) vmcnt(19)
    s_barrier
    ds_read_b128 v[52:55], v16 offset:0
    buffer_load_dwordx4 a[164:167], v24, s[64:67], s22 offen offset:3072 sc1
    ds_read_b128 v[56:59], v17 offset:5120
    ds_read_b128 v[60:63], v18 offset:10240
    ds_read_b128 v[64:67], v16 offset:1024
    ds_read_b128 v[68:71], v17 offset:6144
    ds_read_b128 v[72:75], v18 offset:11264
    ds_read_b128 v[76:79], v16 offset:2048
    ds_read_b128 v[80:83], v17 offset:7168
    ds_read_b128 v[84:87], v18 offset:12288
    ds_read_b128 v[88:91], v16 offset:3072
    ds_read_b128 v[92:95], v17 offset:8192
    ds_read_b128 v[96:99], v18 offset:13312
    ds_read_b128 v[100:103], v16 offset:4096
    ds_read_b128 v[104:107], v17 offset:9216
    ds_read_b128 v[108:111], v18 offset:14336
    s_waitcnt lgkmcnt(12)
    v_pk_add_f32 v[52:53], v[52:53], v[56:57]
    v_pk_add_f32 v[32:33], v[32:33], v[60:61]
    v_pk_add_f32 v[54:55], v[54:55], v[58:59]
    v_pk_add_f32 v[34:35], v[34:35], v[62:63]
    v_pk_add_f32 v[32:33], v[32:33], v[52:53]
    v_pk_add_f32 v[34:35], v[34:35], v[54:55]
    v_pk_mul_f32 v[32:33], v[32:33], v[176:177]
    v_pk_mul_f32 v[34:35], v[34:35], v[178:179]
    s_waitcnt lgkmcnt(9)
    v_pk_add_f32 v[64:65], v[64:65], v[68:69]
    v_pk_add_f32 v[36:37], v[36:37], v[72:73]
    v_pk_add_f32 v[66:67], v[66:67], v[70:71]
    v_pk_add_f32 v[38:39], v[38:39], v[74:75]
    v_pk_add_f32 v[36:37], v[36:37], v[64:65]
    v_pk_add_f32 v[38:39], v[38:39], v[66:67]
    v_pk_mul_f32 v[36:37], v[36:37], v[176:177]
    v_pk_mul_f32 v[38:39], v[38:39], v[178:179]
    s_waitcnt lgkmcnt(6)
    v_pk_add_f32 v[76:77], v[76:77], v[80:81]
    v_pk_add_f32 v[40:41], v[40:41], v[84:85]
    v_pk_add_f32 v[78:79], v[78:79], v[82:83]
    v_pk_add_f32 v[42:43], v[42:43], v[86:87]
    v_pk_add_f32 v[40:41], v[40:41], v[76:77]
    v_pk_add_f32 v[42:43], v[42:43], v[78:79]
    v_pk_mul_f32 v[40:41], v[40:41], v[176:177]
    v_pk_mul_f32 v[42:43], v[42:43], v[178:179]
    s_waitcnt lgkmcnt(3)
    v_pk_add_f32 v[88:89], v[88:89], v[92:93]
    v_pk_add_f32 v[44:45], v[44:45], v[96:97]
    v_pk_add_f32 v[90:91], v[90:91], v[94:95]
    v_pk_add_f32 v[46:47], v[46:47], v[98:99]
    v_pk_add_f32 v[44:45], v[44:45], v[88:89]
    v_pk_add_f32 v[46:47], v[46:47], v[90:91]
    v_pk_mul_f32 v[44:45], v[44:45], v[176:177]
    v_pk_mul_f32 v[46:47], v[46:47], v[178:179]
    s_waitcnt lgkmcnt(0)
    v_pk_add_f32 v[100:101], v[100:101], v[104:105]
    v_pk_add_f32 v[48:49], v[48:49], v[108:109]
    v_pk_add_f32 v[102:103], v[102:103], v[106:107]
    v_pk_add_f32 v[50:51], v[50:51], v[110:111]
    v_pk_add_f32 v[48:49], v[48:49], v[100:101]
    v_pk_add_f32 v[50:51], v[50:51], v[102:103]
    v_pk_mul_f32 v[48:49], v[48:49], v[176:177]
    v_pk_mul_f32 v[50:51], v[50:51], v[178:179]
    s_waitcnt vmcnt(19)
    v_mfma_f32_16x16x32_bf16 v[32:35], a[168:171], a[184:187], v[32:35]
    ds_read_b128 v[112:115], v8 offset:0
    v_mfma_f32_16x16x32_bf16 v[36:39], a[168:171], a[188:191], v[36:39]
    ds_read_b128 v[116:119], v8 offset:5120
    v_mfma_f32_16x16x32_bf16 v[40:43], a[168:171], a[192:195], v[40:43]
    ds_read_b128 v[120:123], v8 offset:10240
    v_mfma_f32_16x16x32_bf16 v[44:47], a[168:171], a[196:199], v[44:47]
    ds_read_b128 v[124:127], v8 offset:15360
    v_mfma_f32_16x16x32_bf16 v[48:51], a[168:171], a[200:203], v[48:51]
    ds_read_b128 v[128:131], v6 offset:20480
    s_waitcnt vmcnt(18)
    v_mfma_f32_16x16x32_bf16 v[32:35], a[172:175], a[204:207], v[32:35]
    ds_read_b128 v[132:135], v6 offset:25600
    v_mfma_f32_16x16x32_bf16 v[36:39], a[172:175], a[208:211], v[36:39]
    ds_read_b128 v[136:139], v6 offset:30720
    v_mfma_f32_16x16x32_bf16 v[40:43], a[172:175], a[212:215], v[40:43]
    ds_read_b128 v[140:143], v6 offset:35840
    v_mfma_f32_16x16x32_bf16 v[44:47], a[172:175], a[216:219], v[44:47]
    ds_read_b128 v[144:147], v8 offset:20480
    v_mfma_f32_16x16x32_bf16 v[48:51], a[172:175], a[220:223], v[48:51]
    ds_read_b128 v[148:151], v8 offset:25600
    s_waitcnt vmcnt(17)
    v_mfma_f32_16x16x32_bf16 v[32:35], a[176:179], a[224:227], v[32:35]
    ds_read_b128 v[152:155], v8 offset:30720
    v_mfma_f32_16x16x32_bf16 v[36:39], a[176:179], a[228:231], v[36:39]
    ds_read_b128 v[156:159], v8 offset:35840
    v_mfma_f32_16x16x32_bf16 v[40:43], a[176:179], a[232:235], v[40:43]
    v_mfma_f32_16x16x32_bf16 v[44:47], a[176:179], a[236:239], v[44:47]
    v_mfma_f32_16x16x32_bf16 v[48:51], a[176:179], a[240:243], v[48:51]
    s_waitcnt vmcnt(16)
    v_mfma_f32_16x16x32_bf16 v[32:35], a[180:183], a[244:247], v[32:35]
    v_mfma_f32_16x16x32_bf16 v[36:39], a[180:183], a[248:251], v[36:39]
    v_mfma_f32_16x16x32_bf16 v[40:43], a[180:183], a[252:255], v[40:43]
    v_mfma_f32_16x16x32_bf16 v[44:47], a[180:183], a[0:3], v[44:47]
    v_mfma_f32_16x16x32_bf16 v[48:51], a[180:183], a[4:7], v[48:51]
    s_waitcnt vmcnt(15) lgkmcnt(11)
    v_mfma_f32_16x16x32_bf16 v[32:35], a[104:107], v[112:115], v[32:35]
    ds_read_b128 v[160:163], v6 offset:0
    s_waitcnt vmcnt(14) lgkmcnt(11)
    v_mfma_f32_16x16x32_bf16 v[32:35], a[108:111], v[116:119], v[32:35]
    ds_read_b128 v[164:167], v6 offset:5120
    s_waitcnt vmcnt(13) lgkmcnt(11)
    v_mfma_f32_16x16x32_bf16 v[32:35], a[112:115], v[120:123], v[32:35]
    ds_read_b128 v[168:171], v6 offset:10240
    s_waitcnt vmcnt(12) lgkmcnt(11)
    v_mfma_f32_16x16x32_bf16 v[32:35], a[116:119], v[124:127], v[32:35]
    ds_read_b128 v[172:175], v6 offset:15360
    s_waitcnt vmcnt(11) lgkmcnt(11)
    v_mfma_f32_16x16x32_bf16 v[32:35], a[120:123], v[128:131], v[32:35]
    ds_read_b128 v[112:115], v8 offset:256
    s_waitcnt vmcnt(10) lgkmcnt(11)
    v_mfma_f32_16x16x32_bf16 v[32:35], a[124:127], v[132:135], v[32:35]
    ds_read_b128 v[116:119], v8 offset:5376
    s_waitcnt vmcnt(9) lgkmcnt(11)
    v_mfma_f32_16x16x32_bf16 v[32:35], a[128:131], v[136:139], v[32:35]
    ds_read_b128 v[120:123], v8 offset:10496
    s_waitcnt vmcnt(8) lgkmcnt(11)
    v_mfma_f32_16x16x32_bf16 v[32:35], a[132:135], v[140:143], v[32:35]
    ds_read_b128 v[124:127], v8 offset:15616
    s_waitcnt vmcnt(7) lgkmcnt(11)
    v_mfma_f32_16x16x32_bf16 v[32:35], a[136:139], v[144:147], v[32:35]
    ds_read_b128 v[128:131], v6 offset:20736
    s_waitcnt vmcnt(6) lgkmcnt(11)
    v_mfma_f32_16x16x32_bf16 v[32:35], a[140:143], v[148:151], v[32:35]
    ds_read_b128 v[132:135], v6 offset:25856
    s_waitcnt vmcnt(5) lgkmcnt(11)
    v_mfma_f32_16x16x32_bf16 v[32:35], a[144:147], v[152:155], v[32:35]
    ds_read_b128 v[136:139], v6 offset:30976
    s_waitcnt vmcnt(4) lgkmcnt(11)
    v_mfma_f32_16x16x32_bf16 v[32:35], a[148:151], v[156:159], v[32:35]
    ds_read_b128 v[140:143], v6 offset:36096
    s_waitcnt vmcnt(3) lgkmcnt(11)
    v_mfma_f32_16x16x32_bf16 v[32:35], a[152:155], v[160:163], v[32:35]
    ds_read_b128 v[144:147], v8 offset:20736
    s_waitcnt vmcnt(2) lgkmcnt(11)
    v_mfma_f32_16x16x32_bf16 v[32:35], a[156:159], v[164:167], v[32:35]
    ds_read_b128 v[148:151], v8 offset:25856
    s_waitcnt vmcnt(1) lgkmcnt(11)
    v_mfma_f32_16x16x32_bf16 v[32:35], a[160:163], v[168:171], v[32:35]
    ds_read_b128 v[152:155], v8 offset:30976
    s_waitcnt vmcnt(0) lgkmcnt(11)
    v_mfma_f32_16x16x32_bf16 v[32:35], a[164:167], v[172:175], v[32:35]
    ds_read_b128 v[156:159], v8 offset:36096
    s_waitcnt lgkmcnt(11)
    v_mfma_f32_16x16x32_bf16 v[36:39], a[104:107], v[112:115], v[36:39]
    ds_read_b128 v[160:163], v6 offset:256
    s_waitcnt lgkmcnt(11)
    v_mfma_f32_16x16x32_bf16 v[36:39], a[108:111], v[116:119], v[36:39]
    ds_read_b128 v[164:167], v6 offset:5376
    s_waitcnt lgkmcnt(11)
    v_mfma_f32_16x16x32_bf16 v[36:39], a[112:115], v[120:123], v[36:39]
    ds_read_b128 v[168:171], v6 offset:10496
    buffer_store_dword v32, v11, s[68:71], 0 offen offset:0 sc1
    s_waitcnt lgkmcnt(11)
    v_mfma_f32_16x16x32_bf16 v[36:39], a[116:119], v[124:127], v[36:39]
    ds_read_b128 v[172:175], v6 offset:15616
    s_waitcnt lgkmcnt(11)
    v_mfma_f32_16x16x32_bf16 v[36:39], a[120:123], v[128:131], v[36:39]
    ds_read_b128 v[112:115], v8 offset:512
    buffer_store_dword v33, v11, s[68:71], 0 offen offset:2560 sc1
    s_waitcnt lgkmcnt(11)
    v_mfma_f32_16x16x32_bf16 v[36:39], a[124:127], v[132:135], v[36:39]
    ds_read_b128 v[116:119], v8 offset:5632
    s_waitcnt lgkmcnt(11)
    v_mfma_f32_16x16x32_bf16 v[36:39], a[128:131], v[136:139], v[36:39]
    ds_read_b128 v[120:123], v8 offset:10752
    buffer_store_dword v34, v12, s[68:71], 0 offen offset:0 sc1
    s_waitcnt lgkmcnt(11)
    v_mfma_f32_16x16x32_bf16 v[36:39], a[132:135], v[140:143], v[36:39]
    ds_read_b128 v[124:127], v8 offset:15872
    s_waitcnt lgkmcnt(11)
    v_mfma_f32_16x16x32_bf16 v[36:39], a[136:139], v[144:147], v[36:39]
    ds_read_b128 v[128:131], v6 offset:20992
    buffer_store_dword v35, v12, s[68:71], 0 offen offset:2560 sc1
    s_waitcnt lgkmcnt(11)
    v_mfma_f32_16x16x32_bf16 v[36:39], a[140:143], v[148:151], v[36:39]
    ds_read_b128 v[132:135], v6 offset:26112
    s_waitcnt lgkmcnt(11)
    v_mfma_f32_16x16x32_bf16 v[36:39], a[144:147], v[152:155], v[36:39]
    ds_read_b128 v[136:139], v6 offset:31232
    s_waitcnt lgkmcnt(11)
    v_mfma_f32_16x16x32_bf16 v[36:39], a[148:151], v[156:159], v[36:39]
    ds_read_b128 v[140:143], v6 offset:36352
    s_waitcnt lgkmcnt(11)
    v_mfma_f32_16x16x32_bf16 v[36:39], a[152:155], v[160:163], v[36:39]
    ds_read_b128 v[144:147], v8 offset:20992
    s_waitcnt lgkmcnt(11)
    v_mfma_f32_16x16x32_bf16 v[36:39], a[156:159], v[164:167], v[36:39]
    ds_read_b128 v[148:151], v8 offset:26112
    s_waitcnt lgkmcnt(11)
    v_mfma_f32_16x16x32_bf16 v[36:39], a[160:163], v[168:171], v[36:39]
    ds_read_b128 v[152:155], v8 offset:31232
    s_waitcnt lgkmcnt(11)
    v_mfma_f32_16x16x32_bf16 v[36:39], a[164:167], v[172:175], v[36:39]
    ds_read_b128 v[156:159], v8 offset:36352
    s_waitcnt lgkmcnt(11)
    v_mfma_f32_16x16x32_bf16 v[40:43], a[104:107], v[112:115], v[40:43]
    ds_read_b128 v[160:163], v6 offset:512
    s_waitcnt lgkmcnt(11)
    v_mfma_f32_16x16x32_bf16 v[40:43], a[108:111], v[116:119], v[40:43]
    ds_read_b128 v[164:167], v6 offset:5632
    s_waitcnt lgkmcnt(11)
    v_mfma_f32_16x16x32_bf16 v[40:43], a[112:115], v[120:123], v[40:43]
    ds_read_b128 v[168:171], v6 offset:10752
    buffer_store_dword v36, v11, s[68:71], 0 offen offset:64 sc1
    s_waitcnt lgkmcnt(11)
    v_mfma_f32_16x16x32_bf16 v[40:43], a[116:119], v[124:127], v[40:43]
    ds_read_b128 v[172:175], v6 offset:15872
    s_waitcnt lgkmcnt(11)
    v_mfma_f32_16x16x32_bf16 v[40:43], a[120:123], v[128:131], v[40:43]
    ds_read_b128 v[112:115], v8 offset:768
    buffer_store_dword v37, v11, s[68:71], 0 offen offset:2624 sc1
    s_waitcnt lgkmcnt(11)
    v_mfma_f32_16x16x32_bf16 v[40:43], a[124:127], v[132:135], v[40:43]
    ds_read_b128 v[116:119], v8 offset:5888
    s_waitcnt lgkmcnt(11)
    v_mfma_f32_16x16x32_bf16 v[40:43], a[128:131], v[136:139], v[40:43]
    ds_read_b128 v[120:123], v8 offset:11008
    buffer_store_dword v38, v12, s[68:71], 0 offen offset:64 sc1
    s_waitcnt lgkmcnt(11)
    v_mfma_f32_16x16x32_bf16 v[40:43], a[132:135], v[140:143], v[40:43]
    ds_read_b128 v[124:127], v8 offset:16128
    s_waitcnt lgkmcnt(11)
    v_mfma_f32_16x16x32_bf16 v[40:43], a[136:139], v[144:147], v[40:43]
    ds_read_b128 v[128:131], v6 offset:21248
    buffer_store_dword v39, v12, s[68:71], 0 offen offset:2624 sc1
    s_waitcnt lgkmcnt(11)
    v_mfma_f32_16x16x32_bf16 v[40:43], a[140:143], v[148:151], v[40:43]
    ds_read_b128 v[132:135], v6 offset:26368
    s_waitcnt lgkmcnt(11)
    v_mfma_f32_16x16x32_bf16 v[40:43], a[144:147], v[152:155], v[40:43]
    ds_read_b128 v[136:139], v6 offset:31488
    s_waitcnt lgkmcnt(11)
    v_mfma_f32_16x16x32_bf16 v[40:43], a[148:151], v[156:159], v[40:43]
    ds_read_b128 v[140:143], v6 offset:36608
    s_waitcnt lgkmcnt(11)
    v_mfma_f32_16x16x32_bf16 v[40:43], a[152:155], v[160:163], v[40:43]
    ds_read_b128 v[144:147], v8 offset:21248
    s_waitcnt lgkmcnt(11)
    v_mfma_f32_16x16x32_bf16 v[40:43], a[156:159], v[164:167], v[40:43]
    ds_read_b128 v[148:151], v8 offset:26368
    s_waitcnt lgkmcnt(11)
    v_mfma_f32_16x16x32_bf16 v[40:43], a[160:163], v[168:171], v[40:43]
    ds_read_b128 v[152:155], v8 offset:31488
    s_waitcnt lgkmcnt(11)
    v_mfma_f32_16x16x32_bf16 v[40:43], a[164:167], v[172:175], v[40:43]
    ds_read_b128 v[156:159], v8 offset:36608
    s_waitcnt lgkmcnt(11)
    v_mfma_f32_16x16x32_bf16 v[44:47], a[104:107], v[112:115], v[44:47]
    ds_read_b128 v[160:163], v6 offset:768
    s_waitcnt lgkmcnt(11)
    v_mfma_f32_16x16x32_bf16 v[44:47], a[108:111], v[116:119], v[44:47]
    ds_read_b128 v[164:167], v6 offset:5888
    s_waitcnt lgkmcnt(11)
    v_mfma_f32_16x16x32_bf16 v[44:47], a[112:115], v[120:123], v[44:47]
    ds_read_b128 v[168:171], v6 offset:11008
    buffer_store_dword v40, v11, s[68:71], 0 offen offset:128 sc1
    s_waitcnt lgkmcnt(11)
    v_mfma_f32_16x16x32_bf16 v[44:47], a[116:119], v[124:127], v[44:47]
    ds_read_b128 v[172:175], v6 offset:16128
    s_waitcnt lgkmcnt(11)
    v_mfma_f32_16x16x32_bf16 v[44:47], a[120:123], v[128:131], v[44:47]
    ds_read_b128 v[112:115], v8 offset:1024
    buffer_store_dword v41, v11, s[68:71], 0 offen offset:2688 sc1
    s_waitcnt lgkmcnt(11)
    v_mfma_f32_16x16x32_bf16 v[44:47], a[124:127], v[132:135], v[44:47]
    ds_read_b128 v[116:119], v8 offset:6144
    s_waitcnt lgkmcnt(11)
    v_mfma_f32_16x16x32_bf16 v[44:47], a[128:131], v[136:139], v[44:47]
    ds_read_b128 v[120:123], v8 offset:11264
    buffer_store_dword v42, v12, s[68:71], 0 offen offset:128 sc1
    s_waitcnt lgkmcnt(11)
    v_mfma_f32_16x16x32_bf16 v[44:47], a[132:135], v[140:143], v[44:47]
    ds_read_b128 v[124:127], v8 offset:16384
    s_waitcnt lgkmcnt(11)
    v_mfma_f32_16x16x32_bf16 v[44:47], a[136:139], v[144:147], v[44:47]
    ds_read_b128 v[128:131], v6 offset:21504
    buffer_store_dword v43, v12, s[68:71], 0 offen offset:2688 sc1
    s_waitcnt lgkmcnt(11)
    v_mfma_f32_16x16x32_bf16 v[44:47], a[140:143], v[148:151], v[44:47]
    ds_read_b128 v[132:135], v6 offset:26624
    s_waitcnt lgkmcnt(11)
    v_mfma_f32_16x16x32_bf16 v[44:47], a[144:147], v[152:155], v[44:47]
    ds_read_b128 v[136:139], v6 offset:31744
    s_waitcnt lgkmcnt(11)
    v_mfma_f32_16x16x32_bf16 v[44:47], a[148:151], v[156:159], v[44:47]
    ds_read_b128 v[140:143], v6 offset:36864
    s_waitcnt lgkmcnt(11)
    v_mfma_f32_16x16x32_bf16 v[44:47], a[152:155], v[160:163], v[44:47]
    ds_read_b128 v[144:147], v8 offset:21504
    s_waitcnt lgkmcnt(11)
    v_mfma_f32_16x16x32_bf16 v[44:47], a[156:159], v[164:167], v[44:47]
    ds_read_b128 v[148:151], v8 offset:26624
    s_waitcnt lgkmcnt(11)
    v_mfma_f32_16x16x32_bf16 v[44:47], a[160:163], v[168:171], v[44:47]
    ds_read_b128 v[152:155], v8 offset:31744
    s_waitcnt lgkmcnt(11)
    v_mfma_f32_16x16x32_bf16 v[44:47], a[164:167], v[172:175], v[44:47]
    ds_read_b128 v[156:159], v8 offset:36864
    s_waitcnt lgkmcnt(11)
    v_mfma_f32_16x16x32_bf16 v[48:51], a[104:107], v[112:115], v[48:51]
    ds_read_b128 v[160:163], v6 offset:1024
    s_waitcnt lgkmcnt(11)
    v_mfma_f32_16x16x32_bf16 v[48:51], a[108:111], v[116:119], v[48:51]
    ds_read_b128 v[164:167], v6 offset:6144
    s_waitcnt lgkmcnt(11)
    v_mfma_f32_16x16x32_bf16 v[48:51], a[112:115], v[120:123], v[48:51]
    ds_read_b128 v[168:171], v6 offset:11264
    buffer_store_dword v44, v11, s[68:71], 0 offen offset:192 sc1
    s_waitcnt lgkmcnt(11)
    v_mfma_f32_16x16x32_bf16 v[48:51], a[116:119], v[124:127], v[48:51]
    ds_read_b128 v[172:175], v6 offset:16384
    s_waitcnt lgkmcnt(11)
    v_mfma_f32_16x16x32_bf16 v[48:51], a[120:123], v[128:131], v[48:51]
    buffer_store_dword v45, v11, s[68:71], 0 offen offset:2752 sc1
    s_waitcnt lgkmcnt(10)
    v_mfma_f32_16x16x32_bf16 v[48:51], a[124:127], v[132:135], v[48:51]
    s_waitcnt lgkmcnt(9)
    v_mfma_f32_16x16x32_bf16 v[48:51], a[128:131], v[136:139], v[48:51]
    buffer_store_dword v46, v12, s[68:71], 0 offen offset:192 sc1
    s_waitcnt lgkmcnt(8)
    v_mfma_f32_16x16x32_bf16 v[48:51], a[132:135], v[140:143], v[48:51]
    s_waitcnt lgkmcnt(7)
    v_mfma_f32_16x16x32_bf16 v[48:51], a[136:139], v[144:147], v[48:51]
    buffer_store_dword v47, v12, s[68:71], 0 offen offset:2752 sc1
    s_waitcnt lgkmcnt(6)
    v_mfma_f32_16x16x32_bf16 v[48:51], a[140:143], v[148:151], v[48:51]
    s_waitcnt lgkmcnt(5)
    v_mfma_f32_16x16x32_bf16 v[48:51], a[144:147], v[152:155], v[48:51]
    s_waitcnt lgkmcnt(4)
    v_mfma_f32_16x16x32_bf16 v[48:51], a[148:151], v[156:159], v[48:51]
    s_waitcnt lgkmcnt(3)
    v_mfma_f32_16x16x32_bf16 v[48:51], a[152:155], v[160:163], v[48:51]
    s_waitcnt lgkmcnt(2)
    v_mfma_f32_16x16x32_bf16 v[48:51], a[156:159], v[164:167], v[48:51]
    s_waitcnt lgkmcnt(1)
    v_mfma_f32_16x16x32_bf16 v[48:51], a[160:163], v[168:171], v[48:51]
    s_waitcnt lgkmcnt(0)
    v_mfma_f32_16x16x32_bf16 v[48:51], a[164:167], v[172:175], v[48:51]
    s_nop 7
    buffer_store_dword v48, v11, s[68:71], 0 offen offset:256 sc1
    buffer_store_dword v49, v11, s[68:71], 0 offen offset:2816 sc1
    buffer_store_dword v50, v12, s[68:71], 0 offen offset:256 sc1
    buffer_store_dword v51, v12, s[68:71], 0 offen offset:2816 sc1
L_end:
    s_endpgm
L_slow_3:
    s_sub_u32 s97, s97, 1
    s_cmp_eq_u32 s97, 0
    s_cbranch_scc1 L_end
    buffer_load_dword v26, off, s[72:75], 0 offset:0 sc1
    s_waitcnt vmcnt(0)
    v_readfirstlane_b32 s29, v26
    s_nop 1
    s_cmp_ge_u32 s29, 1
    s_cbranch_scc0 L_slow_3
    s_branch L_back_4
L_slow_6:
    s_sub_u32 s97, s97, 1
    s_cmp_eq_u32 s97, 0
    s_cbranch_scc1 L_end
    buffer_load_dword v26, v72, s[64:67], 0 offen sc1
    s_waitcnt vmcnt(0)
    v_cmp_gt_u32 vcc, 20, v26
    s_nop 0
    s_cbranch_vccnz L_slow_6
    s_branch L_back_7
L_slow_12:
    s_sub_u32 s97, s97, 1
    s_cmp_eq_u32 s97, 0
    s_cbranch_scc1 L_end
    buffer_load_dword v246, v21, s[76:79], s24 offen offset:3072 sc1
    buffer_load_dword v245, v21, s[76:79], s24 offen offset:2560 sc1
    buffer_load_dword v244, v21, s[76:79], s24 offen offset:2048 sc1
    buffer_load_dword v243, v21, s[76:79], s24 offen offset:1536 sc1
    buffer_load_dword v242, v21, s[76:79], s24 offen offset:1024 sc1
    buffer_load_dword v241, v21, s[76:79], s24 offen offset:512 sc1
    buffer_load_dword v240, v21, s[76:79], s24 offen offset:0 sc1
    buffer_load_dword v239, v21, s[76:79], s17 offen offset:3584 sc1
    buffer_load_dword v238, v21, s[76:79], s17 offen offset:3072 sc1
    buffer_load_dword v237, v21, s[76:79], s17 offen offset:2560 sc1
    buffer_load_dword v236, v21, s[76:79], s17 offen offset:2048 sc1
    buffer_load_dword v235, v21, s[76:79], s17 offen offset:1536 sc1
    buffer_load_dword v234, v21, s[76:79], s17 offen offset:1024 sc1
    buffer_load_dword v233, v21, s[76:79], s17 offen offset:512 sc1
    buffer_load_dword v232, v21, s[76:79], s17 offen offset:0 sc1
    s_waitcnt vmcnt(0)
    v_max3_u32 v247, v232, v233, v234
    v_max3_u32 v247, v247, v235, v236
    v_max3_u32 v247, v247, v237, v238
    v_max3_u32 v247, v247, v239, v240
    v_max3_u32 v247, v247, v241, v242
    v_max3_u32 v247, v247, v243, v244
    v_max3_u32 v247, v247, v245, v246
    v_cmp_eq_u32 vcc, -1, v247
    s_nop 0
    s_cbranch_vccnz L_slow_12
    s_branch L_back_13
L_slow_14:
    s_sub_u32 s97, s97, 1
    s_cmp_eq_u32 s97, 0
    s_cbranch_scc1 L_end
    buffer_load_dwordx4 v[80:83], v20, s[64:67], s25 offen offset:0 sc1
    buffer_load_dwordx4 v[84:87], v20, s[64:67], s25 offen offset:1024 sc1
    buffer_load_dwordx4 v[88:91], v20, s[64:67], s25 offen offset:2048 sc1
    buffer_load_dwordx4 v[92:95], v20, s[64:67], s25 offen offset:3072 sc1
    buffer_load_dwordx4 v[96:99], v22, s[64:67], s25 offen offset:0 sc1
    buffer_load_dwordx4 v[100:103], v22, s[64:67], s25 offen offset:1024 sc1
    buffer_load_dwordx4 v[104:107], v22, s[64:67], s25 offen offset:2048 sc1
    buffer_load_dwordx4 v[108:111], v22, s[64:67], s25 offen offset:3072 sc1
    s_waitcnt vmcnt(0)
    v_mov_b32 v30, 0
    v_max3_u32 v30, v30, v80, v81
    v_max3_u32 v30, v30, v82, v83
    v_max3_u32 v30, v30, v84, v85
    v_max3_u32 v30, v30, v86, v87
    v_max3_u32 v30, v30, v88, v89
    v_max3_u32 v30, v30, v90, v91
    v_max3_u32 v30, v30, v92, v93
    v_max3_u32 v30, v30, v94, v95
    v_max3_u32 v30, v30, v96, v97
    v_max3_u32 v30, v30, v98, v99
    v_max3_u32 v30, v30, v100, v101
    v_max3_u32 v30, v30, v102, v103
    v_max3_u32 v30, v30, v104, v105
    v_max3_u32 v30, v30, v106, v107
    v_max3_u32 v30, v30, v108, v109
    v_max3_u32 v30, v30, v110, v111
    v_cmp_eq_u32 vcc, -1, v30
    s_nop 0
    s_cbranch_vccnz L_slow_14
    v_mfma_f32_16x16x32_bf16 v[224:227], v[216:219], v[80:83], 0
    v_mfma_f32_16x16x32_bf16 v[224:227], v[216:219], v[84:87], v[224:227]
    v_mfma_f32_16x16x32_bf16 v[224:227], v[216:219], v[88:91], v[224:227]
    v_mfma_f32_16x16x32_bf16 v[224:227], v[216:219], v[92:95], v[224:227]
    v_mfma_f32_16x16x32_bf16 v[224:227], v[216:219], v[96:99], v[224:227]
    v_mfma_f32_16x16x32_bf16 v[224:227], v[216:219], v[100:103], v[224:227]
    v_mfma_f32_16x16x32_bf16 v[224:227], v[216:219], v[104:107], v[224:227]
    v_mfma_f32_16x16x32_bf16 v[224:227], v[216:219], v[108:111], v[224:227]
    s_nop 7
    s_branch L_back_15
L_slow_16:
    s_sub_u32 s97, s97, 1
    s_cmp_eq_u32 s97, 0
    s_cbranch_scc1 L_end
    buffer_load_dword v26, off, s[64:67], s40 offset:0 sc1
    s_waitcnt vmcnt(0)
    v_readfirstlane_b32 s29, v26
    s_nop 1
    s_cmp_ge_u32 s29, 32
    s_cbranch_scc0 L_slow_16
    s_branch L_back_17
L_slow_18:
    s_sub_u32 s97, s97, 1
    s_cmp_eq_u32 s97, 0
    s_cbranch_scc1 L_end
    buffer_load_dword v26, off, s[64:67], s45 offset:0 sc1
    s_waitcnt vmcnt(0)
    v_readfirstlane_b32 s29, v26
    s_nop 1
    s_cmp_ge_u32 s29, 16
    s_cbranch_scc0 L_slow_18
    s_branch L_back_19
L_codeend:
.section .rodata,"a"
.p2align 6
.amdhsa_kernel gated_mix__ssm_conv_s5__linear_attn_block__prompt_kernel
  .amdhsa_next_free_vgpr 512
  .amdhsa_next_free_sgpr 102
  .amdhsa_accum_offset 256
  .amdhsa_group_segment_fixed_size 0
  .amdhsa_kernarg_size 128
  .amdhsa_user_sgpr_count 2
  .amdhsa_user_sgpr_kernarg_segment_ptr 1
  .amdhsa_system_sgpr_workgroup_id_x 1
  .amdhsa_float_denorm_mode_32 3
  .amdhsa_float_denorm_mode_16_64 3
.end_amdhsa_kernel
```
